```python
import torch

def _softmax(x, axis=-1):
    return torch.softmax(x, dim=axis)
def _gelu(x):
    return torch.nn.functional.gelu(x, approximate="tanh")
def _silu(x):
    return torch.nn.functional.silu(x)
def _sigmoid(x):
    return torch.sigmoid(x)
def _layernorm(x, axis=-1, eps=1e-5):
    m = x.mean(dim=axis, keepdim=True)
    v = x.var(dim=axis, keepdim=True, unbiased=False)
    return (x - m) / torch.sqrt(v + eps)
def _scatter_add(tgt, idx, src, axis=0):
    return tgt.clone().index_add_(axis, idx, src)
def _segment_sum(src, seg, n):
    out = torch.zeros((n,) + src.shape[1:], dtype=src.dtype)
    return out.index_add_(0, seg, src)
def _pad(x, pw):
    flat = tuple(v for pair in reversed(pw) for v in pair)
    return torch.nn.functional.pad(x, flat)

kernel_name = 'gather_scatter__edge_featured_mpnn_egc__graph'

def setup_inputs():

    _w = (lambda a: (lambda t: t.to(torch.bfloat16) if t.is_floating_point() else t)(torch.as_tensor(a)))
    N, deg, D, De = 10000, 16, 256, max(16, 1)
    E = N * deg
    return {
        "x": _w((lambda *s: torch.randn(*s, dtype=torch.bfloat16) * 0.1)(N, D)),
        "e_attr": _w((lambda *s: torch.randn(*s, dtype=torch.bfloat16) * 0.1)(E, De)),
        "src": _w((lambda lo, hi, *s: torch.randint(lo, hi, s))(0, N, E).to(torch.int64)),
        "dst": _w((lambda lo, hi, *s: torch.randint(lo, hi, s))(0, N, E).to(torch.int64)),
        "u_w": _w((lambda *s: torch.randn(*s, dtype=torch.bfloat16) * 0.05)(D, D)),
        "v_w": _w((lambda *s: torch.randn(*s, dtype=torch.bfloat16) * 0.05)(D, D)),
        "g_w": _w((lambda *s: torch.randn(*s, dtype=torch.bfloat16) * 0.1)(2 * D + De, D)),
    }

def reference(x, e_attr, src, dst, u_w, v_w, g_w):
    N, D = x.shape
    g_in = torch.concatenate([x[dst], x[src], e_attr], axis=-1)
    eta = _sigmoid(g_in @ g_w)
    hv = x @ v_w
    msg = eta * hv[src]
    agg = _segment_sum(msg, dst, N)
    return _silu(x @ u_w + agg)
```

```asm
; @launch grid=(256,1,1) block=(1024,1,1) lds=163840
.amdgcn_target "amdgcn-amd-amdhsa--gfx950"
.text
    .globl gather_scatter__edge_featured_mpnn_egc__graph_kernel
    .p2align 8
    .type gather_scatter__edge_featured_mpnn_egc__graph_kernel,@function
gather_scatter__edge_featured_mpnn_egc__graph_kernel:
    s_cmp_ge_u32 s2, 256
    s_cbranch_scc1 k_end
    s_load_dwordx16 s[4:19], s[0:1], 0
    s_load_dwordx4 s[20:23], s[0:1], 64
    s_getpc_b64 s[64:65]
k_pc:
    s_bfe_u32 s56, s2, 0x50003
    s_lshl_b32 s56, s56, 7
    v_lshl_add_u32 v1, v0, 12, s56
    v_cmp_gt_u32 vcc, k_end-k_pc, v1
    s_and_b64 exec, exec, vcc
    s_cbranch_execz k_nocode
    global_load_dword v121, v1, s[64:65]
k_nocode:
    s_mov_b64 exec, -1
    v_lshrrev_b32 v1, 6, v0
    s_and_b32 s25, s2, 3
    s_lshr_b32 s24, s2, 3
    s_bfe_u32 s56, s2, 0x10002
    s_lshl_b32 s56, s56, 5
    s_add_u32 s24, s24, s56
    v_readfirstlane_b32 s26, v1
    s_mul_i32 s56, s24, 157
    s_sub_u32 s27, 10000, s56
    s_min_u32 s27, s27, 157
    v_and_b32 v120, 63, v0
    v_mov_b32 v126, 163328
    v_mov_b32 v127, 1
    s_cmp_ge_u32 s26, 8
    s_waitcnt lgkmcnt(0)
    s_cbranch_scc1 g_role
    v_mov_b32 v124, 0
    v_mov_b32 v125, 0
    v_lshl_add_u32 v123, v120, 3, v126
    ds_write_b64 v123, v[124:125]
    s_mul_i32 s56, s2, 2500
    s_add_u32 s36, s10, s56
    s_addc_u32 s37, s11, 0
    s_mov_b32 s38, 0x9c4
    s_mov_b32 s39, 0x20000
    v_lshlrev_b32 v122, 2, v0
    buffer_load_dword v2, v122, s[36:39], 0 offen
    buffer_load_dword v3, v122, s[36:39], 0 offen offset:2048
    s_add_u32 s40, s8, s56
    s_addc_u32 s41, s9, 0
    s_mov_b32 s42, 0x9c4
    s_mov_b32 s43, 0x20000
    buffer_load_dword v4, v122, s[40:43], 0 offen
    buffer_load_dword v5, v122, s[40:43], 0 offen offset:2048
    s_waitcnt lgkmcnt(0)
    s_barrier
    s_mul_i32 s56, s2, 20000
    s_add_u32 s44, s6, s56
    s_addc_u32 s45, s7, 0
    s_mov_b32 s46, 0x4e20
    s_mov_b32 s47, 0x20000
    s_and_b32 s56, s2, 31
    s_mul_i32 s57, s56, 43
    s_lshr_b32 s57, s57, 8
    s_mul_i32 s57, s57, 4352
    s_mul_i32 s56, s56, 640
    s_add_u32 s57, s57, s56
    s_lshr_b32 s58, s2, 5
    s_lshl_b32 s56, s58, 1
    s_add_u32 s56, s56, s57
    s_lshl_b32 s56, s56, 9
    s_add_u32 s48, s22, 0x3000000
    s_addc_u32 s49, s23, 0
    s_add_u32 s48, s48, s56
    s_addc_u32 s49, s49, 0
    s_mov_b32 s50, 0x4e400
    s_mov_b32 s51, 0x20000
    s_mul_i32 s56, s58, 49152
    s_add_u32 s56, s56, s57
    s_lshl_b32 s56, s56, 2
    s_add_u32 s52, s22, 0x1400000
    s_addc_u32 s53, s23, 0
    s_add_u32 s52, s52, s56
    s_addc_u32 s53, s53, 0
    s_mov_b32 s54, 0xa00
    s_mov_b32 s55, 0x20000
    v_cmp_gt_u32 vcc, 113, v0
    s_mov_b64 s[60:61], vcc
    v_lshlrev_b32 v17, 4, v0
    v_add_u32 v16, 148480, v17
    v_lshlrev_b32 v91, 1, v0
    v_and_b32 v91, -4, v91
    v_add_u32 v91, 157696, v91
    v_and_b32 v92, 16, v17
    v_lshlrev_b32 v8, 22, v0
    v_add_u32 v9, 0x80000000, v8
    v_mov_b32 v44, 0
    v_lshl_add_u32 v123, v120, 2, v126
    s_movk_i32 s57, -157
    s_mov_b32 s58, 163584
    s_waitcnt vmcnt(2)
    v_mul_u32_u24 v6, 13358, v2
    v_mul_u32_u24 v7, 13358, v3
    v_lshrrev_b32 v6, 21, v6
    v_lshrrev_b32 v7, 21, v7
    v_mad_i32_i24 v2, v6, s57, v2
    v_mad_i32_i24 v3, v7, s57, v3
    v_lshl_add_u32 v6, v6, 2, s58
    v_lshl_add_u32 v7, v7, 2, s58
    ds_add_rtn_u32 v10, v6, v127
    s_mov_b64 exec, s[60:61]
    ds_add_rtn_u32 v11, v7, v127
    s_mov_b64 exec, 1
    ds_add_u32 v126, v127 offset:0
    s_mov_b64 exec, -1
    s_waitcnt vmcnt(0)
    v_mul_u32_u24 v32, 13358, v4
    v_mul_u32_u24 v33, 13358, v5
    v_lshrrev_b32 v32, 21, v32
    v_lshrrev_b32 v33, 21, v33
    v_mad_u32_u24 v32, v32, 3, v4
    v_mad_u32_u24 v33, v33, 3, v5
    v_subrev_u32 v124, 4096, v32
    v_cmp_gt_u32 vcc, 5120, v124
    v_subrev_u32 v124, 5120, v32
    v_min_u32 v32, v32, v124
    v_cndmask_b32 v125, 32, 0, vcc
    v_and_b32 v124, 0xffffffe0, v32
    v_add3_u32 v32, v32, v124, v125
    v_subrev_u32 v124, 4096, v33
    v_cmp_gt_u32 vcc, 5120, v124
    v_subrev_u32 v124, 5120, v33
    v_min_u32 v33, v33, v124
    v_cndmask_b32 v125, 32, 0, vcc
    v_and_b32 v124, 0xffffffe0, v33
    v_add3_u32 v33, v33, v124, v125
    s_branch sp1r
sp1:
    s_cmp_ge_u32 s56, 8
    s_cbranch_scc1 sp1e
sp1r:
    ds_read_b32 v122, v126 offset:0
    s_waitcnt lgkmcnt(0)
    v_readfirstlane_b32 s56, v122
    s_branch sp1
sp1e:
    ds_read_b32 v12, v123 offset:256
    s_mov_b32 s36, s16
    s_mov_b32 s37, s17
    s_mov_b32 s38, 0x42000
    s_mov_b32 s39, 0x20000
    v_or_b32 v8, v8, v2
    v_or_b32 v9, v9, v3
    s_waitcnt lgkmcnt(0)
    v_mov_b32 v13, v12
    s_nop 1
    v_add_u32_dpp v13, v13, v13 row_shr:1 row_mask:0xf bank_mask:0xf bound_ctrl:0
    s_nop 1
    v_add_u32_dpp v13, v13, v13 row_shr:2 row_mask:0xf bank_mask:0xf bound_ctrl:0
    s_nop 1
    v_add_u32_dpp v13, v13, v13 row_shr:4 row_mask:0xf bank_mask:0xf bound_ctrl:0
    s_nop 1
    v_add_u32_dpp v13, v13, v13 row_shr:8 row_mask:0xf bank_mask:0xf bound_ctrl:0
    s_nop 1
    v_add_u32_dpp v13, v13, v13 row_bcast:15 row_mask:0xa bank_mask:0xf
    s_nop 1
    v_add_u32_dpp v13, v13, v13 row_bcast:31 row_mask:0xc bank_mask:0xf
    v_sub_u32 v13, v13, v12
    ds_bpermute_b32 v124, v6, v13
    ds_bpermute_b32 v125, v7, v13
    v_lshl_or_b32 v14, v12, 10, v13
    s_mov_b32 s57, 157696
    v_readlane_b32 s68, v13, 32
    v_lshl_or_b32 v8, v32, 8, v8
    v_lshl_or_b32 v9, v33, 8, v9
    s_waitcnt lgkmcnt(0)
    v_add_u32 v6, v124, v10
    v_add_u32 v7, v125, v11
    v_lshl_add_u32 v2, v6, 2, s57
    v_lshl_add_u32 v3, v7, 2, s57
    ds_write_b32 v2, v8
    s_mov_b64 exec, s[60:61]
    ds_write_b32 v3, v9
    s_mov_b64 exec, 1
    ds_add_rtn_u32 v122, v126, v127 offset:4
    s_mov_b64 exec, -1
    s_waitcnt lgkmcnt(0)
    v_readfirstlane_b32 s56, v122
    s_add_u32 s56, s56, 1
sp2:
    s_cmp_ge_u32 s56, 8
    s_cbranch_scc1 sp2e
sp2r:
    ds_read_b32 v122, v126 offset:4
    s_waitcnt lgkmcnt(0)
    v_readfirstlane_b32 s56, v122
    s_branch sp2
sp2e:
    ds_read_b128 v[64:67], v16 offset:9216
    ds_read_b32 v32, v91 offset:0
    ds_read_b32 v33, v91 offset:1024
    ds_read_b32 v34, v91 offset:2048
    s_lshl_b32 s56, s2, 9
    s_add_u32 s40, s22, 0x1700000
    s_addc_u32 s41, s23, 0
    s_add_u32 s40, s40, s56
    s_addc_u32 s41, s41, 0
    s_mov_b32 s42, 0x200
    s_mov_b32 s43, 0x20000
    v_lshrrev_b32 v122, 5, v120
    v_bfe_u32 v123, v120, 3, 1
    v_cmp_eq_u32 vcc, v122, v123
    v_bfe_u32 v124, v120, 1, 2
    v_bfe_u32 v123, v120, 4, 1
    v_lshl_add_u32 v124, v123, 2, v124
    v_and_b32 v125, 1, v120
    v_cndmask_b32 v124, 15, v124, vcc
    v_lshl_add_u32 v118, v123, 1, v125
    v_lshlrev_b32 v125, 4, v125
    v_mov_b32 v115, 0x3f80
    v_lshlrev_b32 v125, v125, v115
    v_cmp_eq_u32 vcc, 0, v124
    v_cmp_eq_u32 s[64:65], 1, v124
    s_nop 0
    v_cndmask_b32 v96, 0, v125, vcc
    v_cndmask_b32 v97, 0, v125, s[64:65]
    v_cmp_eq_u32 vcc, 2, v124
    v_cmp_eq_u32 s[64:65], 3, v124
    s_nop 0
    v_cndmask_b32 v98, 0, v125, vcc
    v_cndmask_b32 v99, 0, v125, s[64:65]
    v_cmp_eq_u32 vcc, 4, v124
    v_cmp_eq_u32 s[64:65], 5, v124
    s_nop 0
    v_cndmask_b32 v84, 0, v125, vcc
    v_cndmask_b32 v85, 0, v125, s[64:65]
    v_cmp_eq_u32 vcc, 6, v124
    v_cmp_eq_u32 s[64:65], 7, v124
    s_nop 0
    v_cndmask_b32 v86, 0, v125, vcc
    v_cndmask_b32 v87, 0, v125, s[64:65]
    v_bfe_u32 v123, v120, 2, 1
    v_cmp_eq_u32 vcc, v122, v123
    v_mul_u32_u24 v112, 0xaaaa, v123
    v_add_u32 v112, 0x4444, v112
    v_cndmask_b32 v124, 7, v118, vcc
    v_cmp_eq_u32 vcc, 0, v124
    v_bfe_u32 v123, v120, 3, 1
    v_lshl_add_u32 v118, v118, 1, v123
    v_cndmask_b32 v100, 0, v115, vcc
    v_cmp_eq_u32 vcc, 1, v124
    v_bfe_u32 v123, v120, 1, 1
    v_lshl_add_u32 v118, v118, 1, v123
    v_cndmask_b32 v101, 0, v115, vcc
    v_cmp_eq_u32 vcc, 2, v124
    v_lshlrev_b32 v118, 1, v118
    v_lshlrev_b32 v119, 4, v122
    v_cndmask_b32 v102, 0, v115, vcc
    v_cmp_eq_u32 vcc, 3, v124
    v_mov_b32 v113, 0x8888
    s_nop 0
    v_cndmask_b32 v103, 0, v115, vcc
    v_lshlrev_b32 v122, 2, v120
    v_sub_u32 v122, s27, v122
    v_cmp_lt_i32 vcc, 0, v122
    v_mul_u32_u24 v48, 0x80008, v120
    v_add_u32 v48, 0x10000, v48
    v_cndmask_b32 v52, 0, 4, vcc
    v_cmp_lt_i32 vcc, 1, v122
    v_add_u32 v49, 0x20002, v48
    v_add_u32 v50, 0x40004, v48
    v_cndmask_b32 v53, 0, 4, vcc
    v_cmp_lt_i32 vcc, 2, v122
    v_add_u32 v51, 0x60006, v48
    v_mul_u32_u24 v88, 43, v120
    v_cndmask_b32 v54, 0, 4, vcc
    v_cmp_lt_i32 vcc, 3, v122
    v_lshlrev_b32 v89, 9, v120
    v_mov_b32 v2, 0
    v_cndmask_b32 v55, 0, 4, vcc
    v_lshrrev_b32 v88, 8, v88
    v_mul_u32_u24 v88, 4352, v88
    v_mul_u32_u24 v122, 640, v120
    v_add_u32 v88, v88, v122
    s_lshl_b32 s56, s26, 14
    v_lshl_add_u32 v122, v120, 4, s56
    v_add_u32 v123, 0x2000, v122
    s_lshl_b32 s68, s68, 1
    v_cmp_gt_i32 vcc, s68, v0
    s_sub_i32 s68, s68, 512
    s_nop 0
    v_cndmask_b32 v93, v122, v123, vcc
    v_cmp_gt_i32 vcc, s68, v0
    s_sub_i32 s68, s68, 512
    s_nop 0
    v_cndmask_b32 v94, v122, v123, vcc
    v_cmp_gt_i32 vcc, s68, v0
    s_sub_i32 s68, s68, 512
    s_nop 0
    v_cndmask_b32 v95, v122, v123, vcc
    s_lshr_b32 s56, s2, 3
    s_add_u32 s56, s56, 5069
    s_and_b32 s57, s56, -32
    s_add_u32 s56, s56, s57
    s_add_u32 s56, s56, 32
    s_lshl_b32 s56, s56, 8
    v_mov_b32 v40, s56
    v_mov_b32 v44, 0
    v_mov_b32 v60, 0x2c002c0
    v_mov_b32 v41, s56
    v_mov_b32 v45, 0
    v_mov_b32 v61, 0x2c002c0
    v_mov_b32 v42, s56
    v_mov_b32 v46, 0
    v_mov_b32 v62, 0x2c002c0
    v_mov_b32 v43, s56
    v_mov_b32 v47, 0
    v_mov_b32 v63, 0x2c002c0
    ds_write_b128 v16, v[44:47]
    s_lshl_b32 s62, s26, 10
    s_add_u32 s62, s62, 148480
    v_lshl_add_u32 v90, v120, 1, s62
    s_lshl_b32 s58, s26, 14
    s_lshl_b32 s57, s24, 3
    s_add_u32 s58, s58, s57
    s_add_u32 s58, s58, 0x1700000
    v_add_u32 v89, s58, v89
    s_branch sp3r
sp3:
    s_cmp_ge_u32 s56, 8
    s_cbranch_scc1 sp3e
    s_sleep 1
sp3r:
    ds_read_b32 v122, v126 offset:48
    s_waitcnt lgkmcnt(0)
    v_readfirstlane_b32 s56, v122
    s_branch sp3
sp3e:
    s_waitcnt lgkmcnt(1)
    buffer_store_dwordx4 v[64:67], v17, s[52:55], 0 offen sc1
    global_load_dwordx2 v[38:39], v44, s[20:21] offset:32 sc1
    s_waitcnt lgkmcnt(0)
    v_lshrrev_b32 v32, 22, v32
    v_lshl_or_b32 v32, v32, 5, v92
    v_lshrrev_b32 v33, 22, v33
    v_lshl_or_b32 v33, v33, 5, v92
    v_lshrrev_b32 v34, 22, v34
    v_lshl_or_b32 v34, v34, 5, v92
    buffer_load_dwordx4 v[20:23], v32, s[44:47], 0 offen
    buffer_load_dwordx4 v[24:27], v33, s[44:47], 0 offen
    buffer_load_dwordx4 v[28:31], v34, s[44:47], 0 offen
    v_lshlrev_b32 v124, 3, v120
    s_mov_b32 s57, 262144
    s_waitcnt vmcnt(3)
s_nonce:
    v_readfirstlane_b32 s67, v39
    v_readfirstlane_b32 s66, v38
    s_sub_u32 s57, s57, 1
    s_cbranch_scc1 s_nonceok
    s_cmp_lg_u32 s67, 0
    s_cbranch_scc1 s_nonceok
    global_load_dwordx2 v[38:39], v44, s[20:21] offset:32 sc1
    s_waitcnt vmcnt(0)
    s_branch s_nonce
s_nonceok:
    s_and_b32 s63, s67, 0xfff
    v_lshl_or_b32 v14, s63, 20, v14
    v_mov_b32 v15, s66
    s_mov_b64 exec, 1
    ds_write_b64 v126, v[38:39] offset:104
    s_mov_b64 exec, 1
    ds_add_rtn_u32 v122, v126, v127 offset:8
    s_mov_b64 exec, -1
    s_waitcnt lgkmcnt(0)
    v_readfirstlane_b32 s56, v122
    s_add_u32 s56, s56, 1
    s_cmp_lg_u32 s56, 8
    s_cbranch_scc1 s_nopub
    buffer_store_dwordx2 v[14:15], v124, s[40:43], 0 offen sc1
    s_waitcnt vmcnt(1)
    s_branch s_pub
s_nopub:
    s_waitcnt vmcnt(0)
s_pub:
    s_branch sp4r
sp4:
    s_cmp_ge_u32 s56, 4
    s_cbranch_scc1 sp4e
    s_sleep 1
sp4r:
    ds_read_b32 v122, v126 offset:64
    s_waitcnt lgkmcnt(0)
    v_readfirstlane_b32 s56, v122
    s_branch sp4
sp4e:
    s_bfe_u32 s57, s67, 0x1001e
    s_lshl_b32 s57, s57, 21
    s_add_u32 s48, s48, s57
    s_addc_u32 s49, s49, 0
    s_mov_b32 s57, 0x20000
    s_mov_b32 s58, 0x40000
    buffer_store_dwordx4 v[20:23], v93, s[48:51], 0 offen sc1
    buffer_store_dwordx4 v[24:27], v94, s[48:51], s57 offen sc1
    buffer_store_dwordx4 v[28:31], v95, s[48:51], s58 offen sc1
    v_lshrrev_b32 v122, 5, v120
    v_and_b32 v124, 31, v120
    v_lshlrev_b32 v124, 1, v124
    v_lshl_add_u32 v18, v122, 11, v124
    s_and_b32 s56, s26, 3
    s_lshr_b32 s57, s26, 2
    s_lshl_b32 s59, s57, 12
    s_and_b32 s58, s26, 2
    s_lshl_b32 s58, s58, 9
    s_add_u32 s59, s59, s58
    s_and_b32 s58, s26, 1
    s_lshl_b32 s58, s58, 6
    s_add_u32 s59, s59, s58
    s_lshl_b32 s58, s25, 7
    s_add_u32 s59, s59, s58
    s_add_u32 s59, s59, 262144
    buffer_load_ushort v36, v18, s[36:39], s59 offen
    buffer_load_ushort v37, v18, s[36:39], s59 offen offset:512
    s_lshl_b32 s56, s56, 2
    s_lshl_b32 s57, s57, 10
    s_add_u32 s56, s56, s57
    v_lshl_add_u32 v19, v120, 4, s56
    s_lshl_b32 s56, s25, 22
    s_add_u32 s28, s22, s56
    s_addc_u32 s29, s23, 0
    s_or_b32 s29, s29, 0x40000
    s_mov_b32 s30, 0x400000
    s_mov_b32 s31, 0x800000
    s_mov_b32 s32, s18
    s_mov_b32 s33, s19
    s_mov_b32 s34, 0x4e2000
    s_mov_b32 s35, 0x20000
    s_mov_b64 s[18:19], s[66:67]
    s_mul_i32 s56, s26, 196608
    s_add_u32 s52, s22, 0x1400000
    s_addc_u32 s53, s23, 0
    s_add_u32 s52, s52, s56
    s_addc_u32 s53, s53, 0
    s_or_b32 s53, s53, 0x40000
    s_mov_b32 s54, 0xc000
    s_mov_b32 s55, 0x20000
    s_branch sp5r
sp5:
    s_cmp_ge_u32 s56, 8
    s_cbranch_scc1 sp5e
    s_sleep 1
sp5r:
    ds_read_b32 v122, v126 offset:28
    s_waitcnt lgkmcnt(0)
    v_readfirstlane_b32 s56, v122
    s_branch sp5
sp5e:
    ds_write_b128 v17, v[40:43] offset:0
    v_cmp_gt_u32 vcc, 400, v0
    s_mov_b64 exec, vcc
    ds_write_b128 v17, v[60:63] offset:12800
    v_cmp_gt_u32 vcc, 288, v0
    s_mov_b64 exec, vcc
    ds_write_b128 v17, v[40:43] offset:8192
    v_cmp_gt_u32 vcc, 208, v0
    s_mov_b64 exec, vcc
    ds_write_b128 v17, v[44:47] offset:19200
    s_mov_b64 exec, -1
    s_cmp_lg_u32 s26, 7
    s_cbranch_scc1 s_noct
    v_add_u32 v123, 93696, v17
    ds_write_b128 v123, v[96:99]
    ds_write_b128 v123, v[100:103] offset:1024
    ds_write_b128 v123, v[116:119] offset:2048
    ds_write_b128 v123, v[84:87] offset:3072
    ds_write_b128 v123, v[112:115] offset:4096
s_noct:
    s_mov_b64 exec, 1
    ds_add_u32 v126, v127 offset:12
    s_mov_b64 exec, -1
    s_waitcnt vmcnt(0)
    s_mov_b64 exec, 1
    ds_add_rtn_u32 v122, v126, v127 offset:20
    s_mov_b64 exec, -1
    s_waitcnt lgkmcnt(0)
    v_readfirstlane_b32 s56, v122
    s_add_u32 s56, s56, 1
    s_cmp_lg_u32 s56, 8
    s_cbranch_scc1 s_pd
    s_lshl_b32 s56, s2, 3
    s_add_u32 s56, s56, 0x1750000
    s_atomic_swap_x2 s[18:19], s[22:23], s56
    s_mov_b32 s56, 0
s_pd:
    s_setprio 3
    s_mov_b32 exec_hi, 0
    global_load_dwordx2 v[2:3], v89, s[22:23] sc1
    s_mov_b32 s57, 262144
    s_waitcnt vmcnt(0)
s_poll:
    v_lshrrev_b32 v122, 20, v2
    v_cmp_ne_u32 vcc, s18, v3
    v_cmp_ne_u32 s[4:5], s63, v122
    s_or_b64 vcc, vcc, s[4:5]
    s_cbranch_scc0 s_pollok
    s_mov_b64 exec, vcc
    s_sleep 8
    global_load_dwordx2 v[2:3], v89, s[22:23] sc1
    s_sub_u32 s57, s57, 1
    s_waitcnt vmcnt(0)
    s_cbranch_scc0 s_poll
    v_mov_b32 v2, 0
s_pollok:
    s_mov_b64 exec, -1
    v_lshlrev_b32 v36, 16, v36
    v_lshlrev_b32 v37, 16, v37
    v_mul_f32 v36, 0xbfb8aa3b, v36
    v_mul_f32 v37, 0xbfb8aa3b, v37
    v_bfe_u32 v4, v2, 10, 10
    v_and_b32 v2, 0x3ff, v2
    v_mov_b32 v12, v4
    v_add_u32 v88, v88, v2
    v_cvt_pk_bf16_f32 v36, v36, v37
    v_add_u32_dpp v12, v12, v12 row_shr:1 row_mask:0xf bank_mask:0xf bound_ctrl:0
    s_nop 1
    v_add_u32_dpp v12, v12, v12 row_shr:2 row_mask:0xf bank_mask:0xf bound_ctrl:0
    s_nop 1
    v_add_u32_dpp v12, v12, v12 row_shr:4 row_mask:0xf bank_mask:0xf bound_ctrl:0
    s_nop 1
    v_add_u32_dpp v12, v12, v12 row_shr:8 row_mask:0xf bank_mask:0xf bound_ctrl:0
    s_nop 1
    v_add_u32_dpp v12, v12, v12 row_bcast:15 row_mask:0xa bank_mask:0xf
    v_cmp_lt_u32 vcc, 0, v4
    v_sub_u32 v5, v12, v4
    v_readlane_b32 s59, v12, 31
    v_sub_u32 v88, v88, v5
    v_lshl_add_u32 v122, v5, 1, s62
    v_subrev_u32 v12, 161, v12
    s_cmp_gt_u32 s59, 448
    s_cselect_b64 exec, 0, vcc
    ds_write_b16 v122, v88
    s_mov_b64 exec, -1
    ds_read_b128 v[8:11], v16
    v_max_i32 v12, 0, v12
    v_and_b32 v12, 0xffffffe0, v12
    s_mov_b32 exec_lo, 0x80000000
    s_mov_b32 exec_hi, 0
    ds_add_rtn_u32 v122, v126, v12 offset:36
    s_mov_b64 exec, -1
    s_waitcnt lgkmcnt(1)
    v_pk_max_u16 v8, v8, v8 op_sel:[0,0] op_sel_hi:[1,0]
    v_pk_max_u16 v9, v9, v9 op_sel:[0,0] op_sel_hi:[1,0]
    v_pk_max_u16 v10, v10, v10 op_sel:[0,0] op_sel_hi:[1,0]
    v_pk_max_u16 v11, v11, v11 op_sel:[0,0] op_sel_hi:[1,0]
    v_pk_max_u16 v9, v9, v8 op_sel:[0,1] op_sel_hi:[1,1]
    v_pk_max_u16 v10, v10, v9 op_sel:[0,1] op_sel_hi:[1,1]
    v_pk_max_u16 v11, v11, v10 op_sel:[0,1] op_sel_hi:[1,1]
    v_lshrrev_b32 v12, 16, v11
    s_nop 1
    v_max_u32_dpp v12, v12, v12 row_shr:1 row_mask:0xf bank_mask:0xf bound_ctrl:0
    s_nop 1
    v_max_u32_dpp v12, v12, v12 row_shr:2 row_mask:0xf bank_mask:0xf bound_ctrl:0
    s_nop 1
    v_max_u32_dpp v12, v12, v12 row_shr:4 row_mask:0xf bank_mask:0xf bound_ctrl:0
    s_nop 1
    v_max_u32_dpp v12, v12, v12 row_shr:8 row_mask:0xf bank_mask:0xf bound_ctrl:0
    s_nop 1
    v_max_u32_dpp v12, v12, v12 row_bcast:15 row_mask:0xa bank_mask:0xf
    s_nop 1
    v_max_u32_dpp v12, v12, v12 row_bcast:31 row_mask:0xc bank_mask:0xf
    v_mov_b32 v5, 0
    s_waitcnt lgkmcnt(0)
    v_mov_b32_dpp v5, v12 wave_shr:1 row_mask:0xf bank_mask:0xf
    v_readlane_b32 s60, v122, 31
    v_pk_max_u16 v8, v8, v5 op_sel:[0,0] op_sel_hi:[1,0]
    v_pk_max_u16 v9, v9, v5 op_sel:[0,0] op_sel_hi:[1,0]
    v_pk_max_u16 v10, v10, v5 op_sel:[0,0] op_sel_hi:[1,0]
    v_pk_max_u16 v11, v11, v5 op_sel:[0,0] op_sel_hi:[1,0]
    v_pk_add_u16 v56, v8, v48
    v_pk_add_u16 v57, v9, v49
    v_pk_add_u16 v58, v10, v50
    v_pk_add_u16 v59, v11, v51
    ds_write_b128 v16, v[56:59]
    ds_read_u16 v64, v90 offset:0
    ds_read_u16 v65, v90 offset:128
    ds_read_u16 v66, v90 offset:256
    ds_read_u16 v67, v90 offset:384
    ds_read_u16 v68, v90 offset:512
    ds_read_u16 v69, v90 offset:640
    ds_read_u16 v70, v90 offset:768
    ds_read_b32 v123, v126 offset:12
    ds_write_b128 v16, v[8:11]
    s_add_u32 s56, s60, s59
    s_cmp_gt_u32 s56, 1600
    s_cselect_b32 s59, 449, s59
    s_cmp_gt_u32 s59, 448
    s_cbranch_scc0 s_fits
    s_mov_b32 s59, 0
    ds_write_b32 v126, v127 offset:40
s_fits:
    s_sub_i32 s56, s59, 0
    v_cmp_gt_i32 s[4:5], s56, v120
    s_sub_i32 s56, s59, 64
    v_cmp_gt_i32 s[6:7], s56, v120
    s_sub_i32 s56, s59, 128
    v_cmp_gt_i32 s[8:9], s56, v120
    s_sub_i32 s56, s59, 192
    v_cmp_gt_i32 s[10:11], s56, v120
    s_sub_i32 s56, s59, 256
    v_cmp_gt_i32 s[12:13], s56, v120
    s_sub_i32 s56, s59, 320
    v_cmp_gt_i32 s[14:15], s56, v120
    s_sub_i32 s56, s59, 384
    v_cmp_gt_i32 s[16:17], s56, v120
    s_waitcnt lgkmcnt(0)
    s_mov_b64 exec, s[4:5]
    buffer_load_dword v28, v64, s[52:55], 0 idxen sc1
    s_mov_b64 exec, s[6:7]
    buffer_load_dword v29, v65, s[52:55], 0 idxen sc1
    s_mov_b64 exec, s[8:9]
    buffer_load_dword v30, v66, s[52:55], 0 idxen sc1
    s_mov_b64 exec, s[10:11]
    buffer_load_dword v31, v67, s[52:55], 0 idxen sc1
    s_mov_b64 exec, s[12:13]
    buffer_load_dword v32, v68, s[52:55], 0 idxen sc1
    s_mov_b64 exec, s[14:15]
    s_cbranch_execz s_idsdone
    buffer_load_dword v33, v69, s[52:55], 0 idxen sc1
    s_mov_b64 exec, s[16:17]
    s_cbranch_execz s_idsdone
    buffer_load_dword v34, v70, s[52:55], 0 idxen sc1
s_idsdone:
    s_mov_b64 exec, -1
    v_readfirstlane_b32 s56, v123
    v_mov_b32 v124, s60
    v_mov_b32 v125, s59
    v_lshl_add_u32 v2, s26, 3, v126
    s_mov_b64 exec, 1
    ds_write_b64 v2, v[124:125] offset:128
    ds_add_u32 v126, v127 offset:72
    s_mov_b64 exec, -1
    s_setprio 0
    ds_write_b32 v19, v36 offset:22528
sp6:
    s_cmp_ge_u32 s56, 8
    s_cbranch_scc1 sp6e
sp6r:
    ds_read_b32 v122, v126 offset:12
    s_waitcnt lgkmcnt(0)
    v_readfirstlane_b32 s56, v122
    s_branch sp6
sp6e:
    v_lshlrev_b32 v123, 4, v120
    s_mul_i32 s3, s26, 192
    s_add_u32 s3, s3, 3568
    s_waitcnt vmcnt(0)
    v_lshlrev_b32_sdwa v64, 2, v28 dst_sel:DWORD dst_unused:UNUSED_PAD src0_sel:DWORD src1_sel:BYTE_0
    v_lshlrev_b32_sdwa v65, 2, v29 dst_sel:DWORD dst_unused:UNUSED_PAD src0_sel:DWORD src1_sel:BYTE_0
    v_lshlrev_b32_sdwa v66, 2, v30 dst_sel:DWORD dst_unused:UNUSED_PAD src0_sel:DWORD src1_sel:BYTE_0
    v_lshlrev_b32_sdwa v67, 2, v31 dst_sel:DWORD dst_unused:UNUSED_PAD src0_sel:DWORD src1_sel:BYTE_0
    v_lshlrev_b32_sdwa v68, 2, v32 dst_sel:DWORD dst_unused:UNUSED_PAD src0_sel:DWORD src1_sel:BYTE_0
    s_mov_b64 exec, s[4:5]
    ds_add_rtn_u32 v72, v64, v127 offset:19200
    v_and_b32 v28, 0x3fff00, v28
    s_mov_b64 exec, s[6:7]
    ds_add_rtn_u32 v73, v65, v127 offset:19200
    v_and_b32 v29, 0x3fff00, v29
    s_mov_b64 exec, s[8:9]
    ds_add_rtn_u32 v74, v66, v127 offset:19200
    v_and_b32 v30, 0x3fff00, v30
    s_mov_b64 exec, s[10:11]
    ds_add_rtn_u32 v75, v67, v127 offset:19200
    v_and_b32 v31, 0x3fff00, v31
    s_mov_b64 exec, s[12:13]
    ds_add_rtn_u32 v76, v68, v127 offset:19200
    v_and_b32 v32, 0x3fff00, v32
    s_mov_b64 exec, s[14:15]
    s_cbranch_execz s_histdone
    v_lshlrev_b32_sdwa v69, 2, v33 dst_sel:DWORD dst_unused:UNUSED_PAD src0_sel:DWORD src1_sel:BYTE_0
    ds_add_rtn_u32 v77, v69, v127 offset:19200
    v_and_b32 v33, 0x3fff00, v33
    s_mov_b64 exec, s[16:17]
    s_cbranch_execz s_histdone
    v_lshlrev_b32_sdwa v70, 2, v34 dst_sel:DWORD dst_unused:UNUSED_PAD src0_sel:DWORD src1_sel:BYTE_0
    ds_add_rtn_u32 v78, v70, v127 offset:19200
    v_and_b32 v34, 0x3fff00, v34
s_histdone:
    s_mov_b64 exec, 1
    ds_add_rtn_u32 v122, v126, v127 offset:16
    s_mov_b64 exec, -1
    s_waitcnt lgkmcnt(0)
    v_readfirstlane_b32 s56, v122
    s_add_u32 s56, s56, 1
sp7:
    s_cmp_ge_u32 s56, 8
    s_cbranch_scc1 sp7e
sp7r:
    ds_read_b32 v122, v126 offset:16
    s_waitcnt lgkmcnt(0)
    v_readfirstlane_b32 s56, v122
    s_branch sp7
sp7e:
    ds_read_b128 v[56:59], v123 offset:19200
    s_add_u32 s56, s60, 1936
    v_add_u32 v4, s56, v120
    v_add_u32 v5, s3, v120
    v_lshlrev_b32 v124, 2, v0
    s_waitcnt lgkmcnt(0)
    v_add_u32 v56, 3, v56
    v_add_u32 v57, 3, v57
    v_add_u32 v58, 3, v58
    v_add_u32 v59, 3, v59
    v_and_b32 v56, -4, v56
    v_and_b32 v57, -4, v57
    v_and_b32 v58, -4, v58
    v_and_b32 v59, -4, v59
    v_max_u32 v56, v56, v52
    v_max_u32 v57, v57, v53
    v_max_u32 v58, v58, v54
    v_max_u32 v59, v59, v55
    v_add_u32 v57, v56, v57
    v_add_u32 v58, v57, v58
    v_add_u32 v59, v58, v59
    v_mov_b32 v12, v59
    s_nop 1
    v_add_u32_dpp v12, v12, v12 row_shr:1 row_mask:0xf bank_mask:0xf bound_ctrl:0
    s_nop 1
    v_add_u32_dpp v12, v12, v12 row_shr:2 row_mask:0xf bank_mask:0xf bound_ctrl:0
    s_nop 1
    v_add_u32_dpp v12, v12, v12 row_shr:4 row_mask:0xf bank_mask:0xf bound_ctrl:0
    s_nop 1
    v_add_u32_dpp v12, v12, v12 row_shr:8 row_mask:0xf bank_mask:0xf bound_ctrl:0
    s_nop 1
    v_add_u32_dpp v12, v12, v12 row_bcast:15 row_mask:0xa bank_mask:0xf
    s_nop 1
    v_add_u32_dpp v12, v12, v12 row_bcast:31 row_mask:0xc bank_mask:0xf
    v_sub_u32 v60, v12, v59
    v_readlane_b32 s61, v12, 63
    v_add_u32 v61, v60, v56
    v_add_u32 v62, v60, v57
    v_add_u32 v63, v60, v58
    ds_write_b128 v123, v[60:63] offset:20224
    ds_read_b32 v8, v124 offset:20224
    ds_read_b32 v11, v124 offset:20228
    ds_read_b32 v20, v64 offset:20224
    ds_read_b32 v21, v65 offset:20224
    ds_read_b32 v22, v66 offset:20224
    ds_read_b32 v23, v67 offset:20224
    ds_read_b32 v24, v68 offset:20224
    s_mov_b64 exec, s[14:15]
    s_cbranch_execz s_qdone
    ds_read_b32 v25, v69 offset:20224
    s_mov_b64 exec, s[16:17]
    s_cbranch_execz s_qdone
    ds_read_b32 v26, v70 offset:20224
s_qdone:
    s_cmp_gt_u32 s61, 3136
    s_cbranch_scc1 s_ovf
    s_waitcnt lgkmcnt(0)
    s_mov_b64 exec, s[4:5]
    v_add_lshl_u32 v64, v20, v72, 2
    v_add_lshl_u32 v20, v20, v72, 1
    v_add_u32 v72, 0, v5
    ds_write_b32 v64, v28 offset:0
    ds_write_b16 v20, v72 offset:12800
    s_mov_b64 exec, s[6:7]
    v_add_lshl_u32 v65, v21, v73, 2
    v_add_lshl_u32 v21, v21, v73, 1
    v_add_u32 v73, 64, v5
    ds_write_b32 v65, v29 offset:0
    ds_write_b16 v21, v73 offset:12800
    s_mov_b64 exec, s[8:9]
    v_add_lshl_u32 v66, v22, v74, 2
    v_add_lshl_u32 v22, v22, v74, 1
    v_add_u32 v74, 128, v5
    ds_write_b32 v66, v30 offset:0
    ds_write_b16 v22, v74 offset:12800
    s_mov_b64 exec, s[10:11]
    v_add_lshl_u32 v67, v23, v75, 2
    v_add_lshl_u32 v23, v23, v75, 1
    v_add_u32 v75, 192, v4
    ds_write_b32 v67, v31 offset:0
    ds_write_b16 v23, v75 offset:12800
    s_mov_b64 exec, s[12:13]
    s_cbranch_execz s_scatdone
    v_add_lshl_u32 v68, v24, v76, 2
    v_add_lshl_u32 v24, v24, v76, 1
    v_add_u32 v76, 256, v4
    ds_write_b32 v68, v32 offset:0
    ds_write_b16 v24, v76 offset:12800
    s_mov_b64 exec, s[14:15]
    s_cbranch_execz s_scatdone
    v_add_lshl_u32 v69, v25, v77, 2
    v_add_lshl_u32 v25, v25, v77, 1
    v_add_u32 v77, 320, v4
    ds_write_b32 v69, v33 offset:0
    ds_write_b16 v25, v77 offset:12800
    s_mov_b64 exec, s[16:17]
    s_cbranch_execz s_scatdone
    v_add_lshl_u32 v70, v26, v78, 2
    v_add_lshl_u32 v26, v26, v78, 1
    v_add_u32 v78, 384, v4
    ds_write_b32 v70, v34 offset:0
    ds_write_b16 v26, v78 offset:12800
s_scatdone:
    s_mov_b64 exec, -1
    s_cmp_ge_u32 s26, 3
    s_cbranch_scc1 s_fin
    v_cvt_f32_u32 v122, s61
    v_cmp_gt_u32 vcc, s27, v0
    v_rcp_f32 v122, v122
    s_mov_b64 exec, vcc
    v_cvt_f32_u32 v8, v8
    v_cvt_f32_u32 v9, v11
    v_mul_f32 v122, 0x41800000, v122
    v_lshrrev_b32 v125, 2, v11
    v_cmp_eq_u32 vcc, s61, v11
    v_mul_f32 v8, v8, v122
    v_mul_f32 v9, v9, v122
    ds_write_b8 v125, v127 offset:21247
    v_cvt_u32_f32 v8, v8
    v_cvt_u32_f32 v9, v9
    v_min_u32 v8, 15, v8
    v_min_u32 v9, 15, v9
    v_add_u32 v10, 1, v0
    v_cndmask_b32 v9, v9, 16, vcc
s_bnd:
    v_cmp_lt_u32 vcc, v8, v9
    s_and_b64 exec, exec, vcc
    s_cbranch_scc0 s_fin
    v_add_u32 v8, 1, v8
    v_lshlrev_b32 v125, 3, v8
    ds_write_b64 v125, v[10:11] offset:22272
    s_branch s_bnd
s_ovf:
    s_mov_b64 exec, 1
    ds_write_b32 v126, v127 offset:40
s_fin:
    s_mov_b64 exec, 1
    ds_add_u32 v126, v127 offset:68
    s_mov_b64 exec, -1
    s_cmp_lg_u32 s26, 0
    s_cbranch_scc1 k_join
    s_lshl_b32 s57, s25, 9
    s_add_u32 s57, s57, 0x1740000
    v_lshl_add_u32 v2, v120, 3, s57
    v_mov_b32 v3, 0x100
    s_branch sp8r
sp8:
    s_cmp_ge_u32 s56, 4
    s_cbranch_scc1 sp8e
    s_sleep 1
sp8r:
    ds_read_b32 v122, v126 offset:44
    s_waitcnt lgkmcnt(0)
    v_readfirstlane_b32 s56, v122
    s_branch sp8
sp8e:
    s_sleep 8
    global_load_dwordx2 v[4:5], v2, s[22:23] sc1
    s_mov_b32 s57, 262144
s_fp:
    s_waitcnt vmcnt(0)
    v_cmp_ne_u64 vcc, s[18:19], v[4:5]
    s_and_b64 exec, exec, vcc
    s_cbranch_scc0 s_fpe
    s_sleep 4
    global_load_dwordx2 v[4:5], v2, s[22:23] sc1
    s_sub_u32 s57, s57, 1
    s_cbranch_scc0 s_fp
s_fpe:
    s_mov_b64 exec, -1
    s_mov_b64 exec, 1
    ds_add_u32 v126, v3 offset:68
    s_mov_b64 exec, -1
    s_branch k_join
g_role:
    s_sub_u32 s56, s26, 15
    s_or_b32 s69, s56, s2
    s_cbranch_scc1 g_nopr0
    s_mov_b32 s56, 0x6000000
    s_mov_b32 s57, 0x6002000
    s_load_dword s67, s[22:23], s56 glc
    s_load_dword s67, s[22:23], s57 glc
g_nopr0:
    s_cmp_ge_u32 s26, 10
    s_cbranch_scc1 g_nowpf
    s_lshr_b32 s57, s2, 3
    s_mul_i32 s57, s57, 4096
    s_lshl_b32 s56, s25, 7
    s_add_u32 s57, s57, s56
    v_lshl_add_u32 v100, v120, 9, s57
    s_mov_b64 exec, 0xff
    s_cmp_eq_u32 s26, 8
    s_cbranch_scc0 g_wpf2
    global_load_dword v5, v100, s[16:17]
    v_add_u32 v101, 131072, v100
    global_load_dword v6, v101, s[16:17]
    s_branch g_wpf3
g_wpf2:
    global_load_dword v5, v100, s[14:15]
    global_load_dword v6, v100, s[12:13]
g_wpf3:
    s_mov_b64 exec, -1
g_nowpf:
    s_and_b32 s3, s26, 3
    s_and_b32 s61, s26, 7
    s_mov_b32 s40, s16
    s_mov_b32 s41, s17
    s_mov_b32 s42, 0x42000
    s_mov_b32 s43, 0x20000
    s_mov_b32 s44, s14
    s_mov_b32 s45, s15
    s_mov_b32 s46, 0x20000
    s_mov_b32 s47, 0x20000
    v_lshrrev_b32 v99, 3, v120
    v_and_b32 v100, 2, v99
    v_and_b32 v101, 7, v120
    v_xor_b32 v100, v100, v101
    v_lshlrev_b32 v100, 4, v100
    v_lshl_add_u32 v96, v99, 9, v100
    v_xor_b32 v97, 64, v96
    s_mov_b32 s48, s12
    s_mov_b32 s49, s13
    s_mov_b32 s50, 0x20000
    s_mov_b32 s51, 0x20000
    s_mov_b32 s36, s4
    s_mov_b32 s37, s5
    s_mov_b32 s38, 0x4e2000
    s_mov_b32 s39, 0x20000
    v_lshrrev_b32 v99, 5, v120
    v_xor_b32 v100, v99, v120
    v_lshlrev_b32 v125, 4, v100
    s_lshr_b32 s66, s2, 3
    s_and_b32 s66, s66, 31
    s_xor_b32 s66, s66, s61
    s_lshl_b32 s56, s66, 12
    s_lshl_b32 s66, s66, 10
    s_lshl_b32 s57, s25, 7
    s_add_u32 s56, s56, s57
    s_lshl_b32 s58, s61, 10
    s_mul_i32 s63, s24, 80384
    s_add_u32 s64, s63, s58
    s_mul_i32 s62, s61, 1056
    s_barrier
    s_cmp_lg_u32 s69, 0
    s_cbranch_scc1 g_nopr
    s_mov_b32 s60, -1
    s_mov_b32 s68, -1
    s_waitcnt lgkmcnt(0)
    s_memtime s[96:97]
    s_waitcnt lgkmcnt(0)
    s_mov_b32 s57, 0x6000000
    s_load_dword s67, s[22:23], s57 glc
    s_waitcnt lgkmcnt(0)
    s_memtime s[98:99]
    s_waitcnt lgkmcnt(0)
    s_sub_u32 s57, s98, s96
    s_min_u32 s60, s60, s57
    s_mov_b32 s57, 0x6002000
    s_load_dword s67, s[22:23], s57 glc
    s_waitcnt lgkmcnt(0)
    s_memtime s[96:97]
    s_waitcnt lgkmcnt(0)
    s_sub_u32 s57, s96, s98
    s_min_u32 s68, s68, s57
    s_mov_b32 s57, 0x6000000
    s_load_dword s67, s[22:23], s57 glc
    s_waitcnt lgkmcnt(0)
    s_memtime s[98:99]
    s_waitcnt lgkmcnt(0)
    s_sub_u32 s57, s98, s96
    s_min_u32 s60, s60, s57
    s_mov_b32 s57, 0x6002000
    s_load_dword s67, s[22:23], s57 glc
    s_waitcnt lgkmcnt(0)
    s_memtime s[96:97]
    s_waitcnt lgkmcnt(0)
    s_sub_u32 s57, s96, s98
    s_min_u32 s68, s68, s57
    s_memrealtime s[96:97]
    s_cmp_lt_u32 s60, s68
    s_cselect_b32 s57, 1, 0
    s_waitcnt lgkmcnt(0)
    s_and_b32 s57, s57, 1
    s_or_b32 s57, s57, 2
    s_lshl_b32 s57, s57, 30
    s_and_b32 s97, s97, 0x3fffffff
    s_or_b32 s97, s97, s57
    s_atomic_swap_x2 s[96:97], s[20:21], 0x20
g_nopr:
    s_xor_b32 m0, s66, 0
    s_xor_b32 s57, s56, 131072
    buffer_load_dwordx4 v96, s[40:43], s57 offen lds
    s_xor_b32 m0, s66, 8192
    s_xor_b32 s57, s56, 163840
    buffer_load_dwordx4 v96, s[40:43], s57 offen lds
    s_xor_b32 m0, s66, 16384
    s_xor_b32 s57, s56, 196608
    buffer_load_dwordx4 v96, s[40:43], s57 offen lds
    s_xor_b32 m0, s66, 24576
    s_xor_b32 s57, s56, 229376
    buffer_load_dwordx4 v96, s[40:43], s57 offen lds
    s_xor_b32 m0, s66, 32768
    s_xor_b32 s57, s56, 0
    buffer_load_dwordx4 v97, s[44:47], s57 offen lds
    s_xor_b32 m0, s66, 40960
    s_xor_b32 s57, s56, 32768
    buffer_load_dwordx4 v97, s[44:47], s57 offen lds
    s_xor_b32 m0, s66, 49152
    s_xor_b32 s57, s56, 65536
    buffer_load_dwordx4 v97, s[44:47], s57 offen lds
    s_xor_b32 m0, s66, 57344
    s_xor_b32 s57, s56, 98304
    buffer_load_dwordx4 v97, s[44:47], s57 offen lds
    s_xor_b32 m0, s66, 65536
    s_xor_b32 s57, s56, 0
    buffer_load_dwordx4 v96, s[40:43], s57 offen lds
    s_xor_b32 m0, s66, 73728
    s_xor_b32 s57, s56, 32768
    buffer_load_dwordx4 v96, s[40:43], s57 offen lds
    s_xor_b32 m0, s66, 81920
    s_xor_b32 s57, s56, 65536
    buffer_load_dwordx4 v96, s[40:43], s57 offen lds
    s_xor_b32 m0, s66, 90112
    s_xor_b32 s57, s56, 98304
    buffer_load_dwordx4 v96, s[40:43], s57 offen lds
    s_xor_b32 m0, s66, 98304
    s_xor_b32 s57, s56, 0
    buffer_load_dwordx4 v97, s[48:51], s57 offen lds
    s_xor_b32 m0, s66, 106496
    s_xor_b32 s57, s56, 32768
    buffer_load_dwordx4 v97, s[48:51], s57 offen lds
    s_xor_b32 m0, s66, 114688
    s_xor_b32 s57, s56, 65536
    buffer_load_dwordx4 v97, s[48:51], s57 offen lds
    s_xor_b32 m0, s66, 122880
    s_xor_b32 s57, s56, 98304
    buffer_load_dwordx4 v97, s[48:51], s57 offen lds
    s_cmp_lt_u32 s26, 12
    s_cbranch_scc1 g_nox0
    s_add_u32 m0, s62, 131072
    s_add_u32 s57, s64, 0
    buffer_load_dwordx4 v125, s[36:39], s57 offen lds
    s_add_u32 m0, s62, 139520
    s_add_u32 s57, s64, 8192
    buffer_load_dwordx4 v125, s[36:39], s57 offen lds
    s_sub_u32 s62, s62, 4224
    s_sub_u32 s64, s64, 4096
    s_add_u32 m0, s62, 131072
    s_add_u32 s57, s64, 0
    buffer_load_dwordx4 v125, s[36:39], s57 offen lds
    s_add_u32 m0, s62, 139520
    s_add_u32 s57, s64, 8192
    buffer_load_dwordx4 v125, s[36:39], s57 offen lds
g_nox0:
    s_mov_b64 exec, 1
    ds_add_u32 v126, v127 offset:48
    s_mov_b64 exec, -1
    v_bfe_u32 v100, v120, 2, 2
    v_lshl_add_u32 v100, v99, 3, v100
    v_lshlrev_b32 v98, 7, v100
    v_bfe_u32 v100, v120, 3, 2
    v_xor_b32 v100, s3, v100
    v_lshl_add_u32 v98, v100, 5, v98
    v_and_b32 v100, 1, v120
    v_lshl_add_u32 v98, v100, 4, v98
    v_bfe_u32 v101, v120, 1, 1
    v_lshl_add_u32 v98, v101, 3, v98
    v_bfe_u32 v101, v120, 4, 1
    v_lshl_add_u32 v98, v101, 15, v98
    s_cmp_ge_u32 s26, 12
    s_cselect_b32 s57, 0x10000, 0
    v_add_u32 v98, s57, v98
    s_mov_b32 s57, 113152
    s_cselect_b32 s57, 24576, s57
    s_lshl_b32 s56, s3, 6
    s_add_u32 s57, s57, s56
    v_xor_b32 v101, v99, v100
    v_lshlrev_b32 v101, 4, v101
    v_lshl_add_u32 v123, v100, 9, v101
    v_bfe_u32 v100, v120, 1, 4
    v_mul_u32_u24 v100, 1056, v100
    v_add_u32 v123, v123, v100
    v_add_u32 v123, 131072, v123
    v_and_b32 v100, 31, v120
    v_mul_u32_u24 v100, 272, v100
    v_lshl_add_u32 v100, v99, 5, v100
    v_add_u32 v121, s57, v100
    s_lshl_b32 s58, s3, 10
    s_add_u32 s63, s63, s58
    s_mul_i32 s62, s3, 1056
    v_lshl_add_u32 v120, v120, 4, s58
    v_lshrrev_b32 v100, 8, v120
    v_lshl_add_u32 v100, v100, 4, v120
    v_add_u32 v124, 113152, v100
    s_and_b32 s57, s24, 31
    s_mul_i32 s65, s57, 81920
    s_cmp_lt_u32 s24, 32
    s_cselect_b32 s67, 0x2000, 0
    s_add_u32 s65, s65, s67
    s_lshl_b32 s56, s25, 22
    s_add_u32 s52, s22, s56
    s_addc_u32 s53, s23, 0
    s_mov_b32 s54, 0x280000
    s_mov_b32 s55, 0x20000
    s_lshl_b32 s56, s25, 22
    s_add_u32 s28, s22, s56
    s_addc_u32 s29, s23, 0
    s_or_b32 s29, s29, 0x40000
    s_mov_b32 s30, 0x400000
    s_mov_b32 s31, 0x800000
    s_mov_b32 s32, s18
    s_mov_b32 s33, s19
    s_mov_b32 s34, 0x4e2000
    s_mov_b32 s35, 0x20000
    s_mov_b32 s59, 0x07060100
    s_mov_b32 s60, 0x07060302
    s_waitcnt vmcnt(4)
    s_cmp_ge_u32 s26, 12
    s_cbranch_scc1 g_ww
    s_waitcnt vmcnt(0)
g_ww:
    s_mov_b64 exec, 1
    ds_add_rtn_u32 v122, v126, v127 offset:24
    s_mov_b64 exec, -1
    s_waitcnt lgkmcnt(0)
    v_readfirstlane_b32 s56, v122
    s_add_u32 s56, s56, 1
sp9:
    s_cmp_ge_u32 s56, 8
    s_cbranch_scc1 sp9e
sp9r:
    ds_read_b32 v122, v126 offset:24
    s_waitcnt lgkmcnt(0)
    v_readfirstlane_b32 s56, v122
    s_branch sp9
sp9e:
    ds_read_b64_tr_b16 v[0:1], v98 offset:0
    ds_read_b64_tr_b16 v[2:3], v98 offset:512
    ds_read_b64_tr_b16 v[4:5], v98 offset:2048
    ds_read_b64_tr_b16 v[6:7], v98 offset:2560
    ds_read_b64_tr_b16 v[8:9], v98 offset:4096
    ds_read_b64_tr_b16 v[10:11], v98 offset:4608
    ds_read_b64_tr_b16 v[12:13], v98 offset:6144
    ds_read_b64_tr_b16 v[14:15], v98 offset:6656
    ds_read_b64_tr_b16 v[16:17], v98 offset:8192
    ds_read_b64_tr_b16 v[18:19], v98 offset:8704
    ds_read_b64_tr_b16 v[20:21], v98 offset:10240
    ds_read_b64_tr_b16 v[22:23], v98 offset:10752
    ds_read_b64_tr_b16 v[24:25], v98 offset:12288
    ds_read_b64_tr_b16 v[26:27], v98 offset:12800
    ds_read_b64_tr_b16 v[28:29], v98 offset:14336
    ds_read_b64_tr_b16 v[30:31], v98 offset:14848
    ds_read_b64_tr_b16 v[32:33], v98 offset:16384
    ds_read_b64_tr_b16 v[34:35], v98 offset:16896
    ds_read_b64_tr_b16 v[36:37], v98 offset:18432
    ds_read_b64_tr_b16 v[38:39], v98 offset:18944
    ds_read_b64_tr_b16 v[40:41], v98 offset:20480
    ds_read_b64_tr_b16 v[42:43], v98 offset:20992
    ds_read_b64_tr_b16 v[44:45], v98 offset:22528
    ds_read_b64_tr_b16 v[46:47], v98 offset:23040
    ds_read_b64_tr_b16 v[48:49], v98 offset:24576
    ds_read_b64_tr_b16 v[50:51], v98 offset:25088
    ds_read_b64_tr_b16 v[52:53], v98 offset:26624
    ds_read_b64_tr_b16 v[54:55], v98 offset:27136
    ds_read_b64_tr_b16 v[56:57], v98 offset:28672
    ds_read_b64_tr_b16 v[58:59], v98 offset:29184
    ds_read_b64_tr_b16 v[60:61], v98 offset:30720
    ds_read_b64_tr_b16 v[62:63], v98 offset:31232
    s_waitcnt vmcnt(0)
    s_mov_b64 exec, 1
    ds_add_rtn_u32 v122, v126, v127 offset:28
    s_mov_b64 exec, -1
    s_waitcnt lgkmcnt(0)
    v_readfirstlane_b32 s56, v122
    s_add_u32 s56, s56, 1
sp10:
    s_cmp_ge_u32 s56, 8
    s_cbranch_scc1 sp10e
sp10r:
    ds_read_b32 v122, v126 offset:28
    s_waitcnt lgkmcnt(0)
    v_readfirstlane_b32 s56, v122
    s_branch sp10
sp10e:
    s_cmp_ge_u32 s26, 12
    s_cbranch_scc1 a_role
    v_add_u32 v125, 0x2200, v124
    s_setprio 2
    ds_read_b128 v[96:99], v123 offset:0
    ds_read_b128 v[100:103], v123 offset:32
    ds_read_b128 v[104:107], v123 offset:64
    ds_read_b128 v[108:111], v123 offset:96
    ds_read_b128 v[112:115], v123 offset:128
    ds_read_b128 v[116:119], v123 offset:160
    s_waitcnt lgkmcnt(4)
    v_mfma_f32_32x32x16_bf16 v[64:79], v[0:3], v[96:99], 0
    ds_read_b128 v[96:99], v123 offset:192
    v_mfma_f32_32x32x16_bf16 v[64:79], v[4:7], v[100:103], v[64:79]
    ds_read_b128 v[100:103], v123 offset:224
    s_waitcnt lgkmcnt(4)
    v_mfma_f32_32x32x16_bf16 v[64:79], v[8:11], v[104:107], v[64:79]
    ds_read_b128 v[104:107], v123 offset:256
    v_mfma_f32_32x32x16_bf16 v[64:79], v[12:15], v[108:111], v[64:79]
    s_mov_b64 exec, 1
    ds_add_u32 v126, v127 offset:80
    s_mov_b64 exec, -1
    ds_read_b128 v[108:111], v123 offset:288
    s_waitcnt lgkmcnt(5)
    v_mfma_f32_32x32x16_bf16 v[64:79], v[16:19], v[112:115], v[64:79]
    ds_read_b128 v[112:115], v123 offset:320
    v_mfma_f32_32x32x16_bf16 v[64:79], v[20:23], v[116:119], v[64:79]
    ds_read_b128 v[116:119], v123 offset:352
    s_waitcnt lgkmcnt(5)
    v_mfma_f32_32x32x16_bf16 v[64:79], v[24:27], v[96:99], v[64:79]
    ds_read_b128 v[96:99], v123 offset:384
    v_mfma_f32_32x32x16_bf16 v[64:79], v[28:31], v[100:103], v[64:79]
    ds_read_b32 v122, v126 offset:80
    ds_read_b128 v[100:103], v123 offset:416
    s_waitcnt lgkmcnt(5)
    v_mfma_f32_32x32x16_bf16 v[64:79], v[32:35], v[104:107], v[64:79]
    ds_read_b128 v[104:107], v123 offset:448
    v_mfma_f32_32x32x16_bf16 v[64:79], v[36:39], v[108:111], v[64:79]
    ds_read_b128 v[108:111], v123 offset:480
    s_waitcnt lgkmcnt(5)
    v_mfma_f32_32x32x16_bf16 v[64:79], v[40:43], v[112:115], v[64:79]
    s_waitcnt lgkmcnt(3)
    v_readfirstlane_b32 s56, v122
sp11:
    s_and_b32 s56, s56, 0xf0f
    s_cmp_ge_u32 s56, 1028
    s_cbranch_scc1 sp11e
    s_sleep 1
sp11r:
    ds_read_b32 v122, v126 offset:80
    s_waitcnt lgkmcnt(0)
    v_readfirstlane_b32 s56, v122
    s_branch sp11
sp11e:
    v_add_u32 v123, 0xfffe8200, v123
    ds_read_b128 v[112:115], v123 offset:0
    v_mfma_f32_32x32x16_bf16 v[64:79], v[44:47], v[116:119], v[64:79]
    ds_read_b128 v[116:119], v123 offset:32
    s_waitcnt lgkmcnt(4)
    v_mfma_f32_32x32x16_bf16 v[64:79], v[48:51], v[96:99], v[64:79]
    ds_read_b128 v[96:99], v123 offset:64
    v_mfma_f32_32x32x16_bf16 v[64:79], v[52:55], v[100:103], v[64:79]
    ds_read_b128 v[100:103], v123 offset:96
    s_waitcnt lgkmcnt(4)
    v_mfma_f32_32x32x16_bf16 v[64:79], v[56:59], v[104:107], v[64:79]
    ds_read_b128 v[104:107], v123 offset:128
    v_mfma_f32_32x32x16_bf16 v[64:79], v[60:63], v[108:111], v[64:79]
    ds_read_b128 v[108:111], v123 offset:160
    s_waitcnt lgkmcnt(4)
    v_mfma_f32_32x32x16_bf16 v[80:95], v[0:3], v[112:115], 0
    ds_read_b128 v[112:115], v123 offset:192
    v_mfma_f32_32x32x16_bf16 v[80:95], v[4:7], v[116:119], v[80:95]
    ds_read_b128 v[116:119], v123 offset:224
    s_waitcnt lgkmcnt(4)
    v_mfma_f32_32x32x16_bf16 v[80:95], v[8:11], v[96:99], v[80:95]
    s_nop 5
    v_mul_f32 v64, 0xbfb8aa3b, v64
    v_mul_f32 v65, 0xbfb8aa3b, v65
    v_mul_f32 v66, 0xbfb8aa3b, v66
    ds_read_b128 v[96:99], v123 offset:256
    v_mfma_f32_32x32x16_bf16 v[80:95], v[12:15], v[100:103], v[80:95]
    v_mul_f32 v67, 0xbfb8aa3b, v67
    v_mul_f32 v68, 0xbfb8aa3b, v68
    v_mul_f32 v69, 0xbfb8aa3b, v69
    s_mov_b64 exec, 1
    ds_add_u32 v126, v127 offset:84
    s_mov_b64 exec, -1
    ds_read_b128 v[100:103], v123 offset:288
    s_waitcnt lgkmcnt(5)
    v_mfma_f32_32x32x16_bf16 v[80:95], v[16:19], v[104:107], v[80:95]
    v_mul_f32 v70, 0xbfb8aa3b, v70
    v_mul_f32 v71, 0xbfb8aa3b, v71
    v_add_u32 v72, 0xa008000, v72
    ds_read_b128 v[104:107], v123 offset:320
    v_mfma_f32_32x32x16_bf16 v[80:95], v[20:23], v[108:111], v[80:95]
    v_add_u32 v73, 0xa008000, v73
    v_add_u32 v74, 0xa008000, v74
    v_add_u32 v75, 0xa008000, v75
    ds_read_b128 v[108:111], v123 offset:352
    s_waitcnt lgkmcnt(5)
    v_mfma_f32_32x32x16_bf16 v[80:95], v[24:27], v[112:115], v[80:95]
    v_add_u32 v76, 0xa008000, v76
    v_add_u32 v77, 0xa008000, v77
    v_add_u32 v78, 0xa008000, v78
    ds_read_b128 v[112:115], v123 offset:384
    v_mfma_f32_32x32x16_bf16 v[80:95], v[28:31], v[116:119], v[80:95]
    v_add_u32 v79, 0xa008000, v79
    v_cvt_pk_bf16_f32 v64, v64, v65
    v_cvt_pk_bf16_f32 v66, v66, v67
    ds_read_b32 v122, v126 offset:84
    ds_read_b128 v[116:119], v123 offset:416
    s_waitcnt lgkmcnt(5)
    v_mfma_f32_32x32x16_bf16 v[80:95], v[32:35], v[96:99], v[80:95]
    v_cvt_pk_bf16_f32 v68, v68, v69
    v_cvt_pk_bf16_f32 v70, v70, v71
    v_sub_u32_sdwa v72, v72, v64 dst_sel:DWORD dst_unused:UNUSED_PAD src0_sel:DWORD src1_sel:WORD_0
    ds_read_b128 v[96:99], v123 offset:448
    v_mfma_f32_32x32x16_bf16 v[80:95], v[36:39], v[100:103], v[80:95]
    v_sub_u32_sdwa v73, v73, v64 dst_sel:DWORD dst_unused:UNUSED_PAD src0_sel:DWORD src1_sel:WORD_1
    v_sub_u32_sdwa v74, v74, v66 dst_sel:DWORD dst_unused:UNUSED_PAD src0_sel:DWORD src1_sel:WORD_0
    v_sub_u32_sdwa v75, v75, v66 dst_sel:DWORD dst_unused:UNUSED_PAD src0_sel:DWORD src1_sel:WORD_1
    ds_read_b128 v[100:103], v123 offset:480
    s_waitcnt lgkmcnt(5)
    v_mfma_f32_32x32x16_bf16 v[80:95], v[40:43], v[104:107], v[80:95]
    v_sub_u32_sdwa v76, v76, v68 dst_sel:DWORD dst_unused:UNUSED_PAD src0_sel:DWORD src1_sel:WORD_0
    v_sub_u32_sdwa v77, v77, v68 dst_sel:DWORD dst_unused:UNUSED_PAD src0_sel:DWORD src1_sel:WORD_1
    v_sub_u32_sdwa v78, v78, v70 dst_sel:DWORD dst_unused:UNUSED_PAD src0_sel:DWORD src1_sel:WORD_0
    s_waitcnt lgkmcnt(3)
    v_readfirstlane_b32 s56, v122
sp12:
    s_and_b32 s56, s56, 0xf0f
    s_cmp_ge_u32 s56, 1028
    s_cbranch_scc1 sp12e
    s_sleep 1
sp12r:
    ds_read_b32 v122, v126 offset:84
    s_waitcnt lgkmcnt(0)
    v_readfirstlane_b32 s56, v122
    s_branch sp12
sp12e:
    ds_read_b128 v[104:107], v123 offset:16896
    v_mfma_f32_32x32x16_bf16 v[80:95], v[44:47], v[108:111], v[80:95]
    v_sub_u32_sdwa v79, v79, v70 dst_sel:DWORD dst_unused:UNUSED_PAD src0_sel:DWORD src1_sel:WORD_1
    v_perm_b32 v72, v72, v64, s59
    v_perm_b32 v73, v73, v64, s60
    ds_read_b128 v[108:111], v123 offset:16928
    s_waitcnt lgkmcnt(4)
    v_mfma_f32_32x32x16_bf16 v[80:95], v[48:51], v[112:115], v[80:95]
    v_perm_b32 v74, v74, v66, s59
    v_perm_b32 v75, v75, v66, s60
    v_perm_b32 v76, v76, v68, s59
    ds_read_b128 v[112:115], v123 offset:16960
    v_mfma_f32_32x32x16_bf16 v[80:95], v[52:55], v[116:119], v[80:95]
    v_perm_b32 v77, v77, v68, s60
    v_perm_b32 v78, v78, v70, s59
    v_perm_b32 v79, v79, v70, s60
    ds_read_b128 v[116:119], v123 offset:16992
    s_waitcnt lgkmcnt(4)
    v_mfma_f32_32x32x16_bf16 v[80:95], v[56:59], v[96:99], v[80:95]
    ds_write_b128 v121, v[72:75] offset:0
    ds_write_b128 v121, v[76:79] offset:16
    v_add_u32 v121, 0x2200, v121
    ds_read_b128 v[96:99], v123 offset:17024
    v_mfma_f32_32x32x16_bf16 v[80:95], v[60:63], v[100:103], v[80:95]
    ds_read_b128 v[100:103], v123 offset:17056
    s_waitcnt lgkmcnt(6)
    v_mfma_f32_32x32x16_bf16 v[64:79], v[0:3], v[104:107], 0
    s_branch sp13r
sp13:
    s_cmp_ge_u32 s56, 1
    s_cbranch_scc1 sp13e
    s_sleep 1
sp13r:
    ds_read_b32 v122, v126 offset:8
    s_waitcnt lgkmcnt(0)
    v_readfirstlane_b32 s56, v122
    s_branch sp13
sp13e:
    ds_read_b32 v122, v126 offset:108
    s_waitcnt lgkmcnt(0)
    v_readfirstlane_b32 s68, v122
    s_bfe_u32 s68, s68, 0x1001e
    s_lshl_b32 s68, s68, 21
    s_add_u32 s52, s52, s68
    s_addc_u32 s53, s53, 0
    ds_read_b128 v[104:107], v123 offset:17088
    v_mfma_f32_32x32x16_bf16 v[64:79], v[4:7], v[108:111], v[64:79]
    ds_read_b128 v[108:111], v123 offset:17120
    s_waitcnt lgkmcnt(6)
    v_mfma_f32_32x32x16_bf16 v[64:79], v[8:11], v[112:115], v[64:79]
    s_nop 5
    v_mul_f32 v80, 0xbfb8aa3b, v80
    v_mul_f32 v81, 0xbfb8aa3b, v81
    v_mul_f32 v82, 0xbfb8aa3b, v82
    ds_read_b128 v[112:115], v123 offset:17152
    v_mfma_f32_32x32x16_bf16 v[64:79], v[12:15], v[116:119], v[64:79]
    v_mul_f32 v83, 0xbfb8aa3b, v83
    v_mul_f32 v84, 0xbfb8aa3b, v84
    v_mul_f32 v85, 0xbfb8aa3b, v85
    s_mov_b64 exec, 1
    ds_add_u32 v126, v127 offset:88
    s_mov_b64 exec, -1
    ds_read_b128 v[116:119], v123 offset:17184
    s_waitcnt lgkmcnt(5)
    v_mfma_f32_32x32x16_bf16 v[64:79], v[16:19], v[96:99], v[64:79]
    v_mul_f32 v86, 0xbfb8aa3b, v86
    v_mul_f32 v87, 0xbfb8aa3b, v87
    v_add_u32 v88, 0xa008000, v88
    ds_read_b128 v[96:99], v123 offset:17216
    v_mfma_f32_32x32x16_bf16 v[64:79], v[20:23], v[100:103], v[64:79]
    v_add_u32 v89, 0xa008000, v89
    v_add_u32 v90, 0xa008000, v90
    v_add_u32 v91, 0xa008000, v91
    ds_read_b128 v[100:103], v123 offset:17248
    s_waitcnt lgkmcnt(5)
    v_mfma_f32_32x32x16_bf16 v[64:79], v[24:27], v[104:107], v[64:79]
    v_add_u32 v92, 0xa008000, v92
    v_add_u32 v93, 0xa008000, v93
    v_add_u32 v94, 0xa008000, v94
    ds_read_b128 v[104:107], v123 offset:17280
    v_mfma_f32_32x32x16_bf16 v[64:79], v[28:31], v[108:111], v[64:79]
    v_add_u32 v95, 0xa008000, v95
    v_cvt_pk_bf16_f32 v80, v80, v81
    v_cvt_pk_bf16_f32 v82, v82, v83
    ds_read_b32 v122, v126 offset:88
    ds_read_b128 v[108:111], v123 offset:17312
    s_waitcnt lgkmcnt(5)
    v_mfma_f32_32x32x16_bf16 v[64:79], v[32:35], v[112:115], v[64:79]
    v_cvt_pk_bf16_f32 v84, v84, v85
    v_cvt_pk_bf16_f32 v86, v86, v87
    v_sub_u32_sdwa v88, v88, v80 dst_sel:DWORD dst_unused:UNUSED_PAD src0_sel:DWORD src1_sel:WORD_0
    ds_read_b128 v[112:115], v123 offset:17344
    v_mfma_f32_32x32x16_bf16 v[64:79], v[36:39], v[116:119], v[64:79]
    v_sub_u32_sdwa v89, v89, v80 dst_sel:DWORD dst_unused:UNUSED_PAD src0_sel:DWORD src1_sel:WORD_1
    v_sub_u32_sdwa v90, v90, v82 dst_sel:DWORD dst_unused:UNUSED_PAD src0_sel:DWORD src1_sel:WORD_0
    v_sub_u32_sdwa v91, v91, v82 dst_sel:DWORD dst_unused:UNUSED_PAD src0_sel:DWORD src1_sel:WORD_1
    ds_read_b128 v[116:119], v123 offset:17376
    s_waitcnt lgkmcnt(5)
    v_mfma_f32_32x32x16_bf16 v[64:79], v[40:43], v[96:99], v[64:79]
    v_sub_u32_sdwa v92, v92, v84 dst_sel:DWORD dst_unused:UNUSED_PAD src0_sel:DWORD src1_sel:WORD_0
    v_sub_u32_sdwa v93, v93, v84 dst_sel:DWORD dst_unused:UNUSED_PAD src0_sel:DWORD src1_sel:WORD_1
    v_sub_u32_sdwa v94, v94, v86 dst_sel:DWORD dst_unused:UNUSED_PAD src0_sel:DWORD src1_sel:WORD_0
    s_waitcnt lgkmcnt(3)
    v_readfirstlane_b32 s56, v122
sp14:
    s_and_b32 s56, s56, 0xf0f
    s_cmp_ge_u32 s56, 1028
    s_cbranch_scc1 sp14e
    s_sleep 1
sp14r:
    ds_read_b32 v122, v126 offset:88
    s_waitcnt lgkmcnt(0)
    v_readfirstlane_b32 s56, v122
    s_branch sp14
sp14e:
    ds_read_b128 v[96:99], v123 offset:33792
    v_mfma_f32_32x32x16_bf16 v[64:79], v[44:47], v[100:103], v[64:79]
    v_sub_u32_sdwa v95, v95, v86 dst_sel:DWORD dst_unused:UNUSED_PAD src0_sel:DWORD src1_sel:WORD_1
    v_perm_b32 v88, v88, v80, s59
    v_perm_b32 v89, v89, v80, s60
    ds_read_b128 v[100:103], v123 offset:33824
    s_waitcnt lgkmcnt(4)
    v_mfma_f32_32x32x16_bf16 v[64:79], v[48:51], v[104:107], v[64:79]
    v_perm_b32 v90, v90, v82, s59
    v_perm_b32 v91, v91, v82, s60
    v_perm_b32 v92, v92, v84, s59
    ds_read_b128 v[104:107], v123 offset:33856
    v_mfma_f32_32x32x16_bf16 v[64:79], v[52:55], v[108:111], v[64:79]
    v_perm_b32 v93, v93, v84, s60
    v_perm_b32 v94, v94, v86, s59
    v_perm_b32 v95, v95, v86, s60
    ds_read_b128 v[80:83], v124 offset:0
    ds_read_b128 v[84:87], v124 offset:4352
    ds_read_b128 v[108:111], v123 offset:33888
    s_waitcnt lgkmcnt(6)
    v_mfma_f32_32x32x16_bf16 v[64:79], v[56:59], v[112:115], v[64:79]
    ds_write_b128 v121, v[88:91] offset:0
    ds_write_b128 v121, v[92:95] offset:16
    v_add_u32 v121, 0xffffde00, v121
    ds_read_b128 v[112:115], v123 offset:33920
    v_mfma_f32_32x32x16_bf16 v[64:79], v[60:63], v[116:119], v[64:79]
    s_add_u32 s56, s65, 0
    s_lshr_b32 s57, s56, 8
    s_and_b32 s57, s57, 0x2000
    s_xor_b32 s56, s56, s57
    s_add_u32 s57, s56, 4096
    s_waitcnt lgkmcnt(4)
    buffer_store_dwordx4 v[80:83], v120, s[52:55], s56 offen sc1
    buffer_store_dwordx4 v[84:87], v120, s[52:55], s57 offen sc1
    ds_read_b128 v[116:119], v123 offset:33952
    s_waitcnt lgkmcnt(8)
    v_mfma_f32_32x32x16_bf16 v[80:95], v[0:3], v[96:99], 0
    ds_read_b128 v[96:99], v123 offset:33984
    v_mfma_f32_32x32x16_bf16 v[80:95], v[4:7], v[100:103], v[80:95]
    ds_read_b128 v[100:103], v123 offset:34016
    s_waitcnt lgkmcnt(6)
    v_mfma_f32_32x32x16_bf16 v[80:95], v[8:11], v[104:107], v[80:95]
    s_nop 5
    v_mul_f32 v64, 0xbfb8aa3b, v64
    v_mul_f32 v65, 0xbfb8aa3b, v65
    v_mul_f32 v66, 0xbfb8aa3b, v66
    ds_read_b128 v[104:107], v123 offset:34048
    v_mfma_f32_32x32x16_bf16 v[80:95], v[12:15], v[108:111], v[80:95]
    v_mul_f32 v67, 0xbfb8aa3b, v67
    v_mul_f32 v68, 0xbfb8aa3b, v68
    v_mul_f32 v69, 0xbfb8aa3b, v69
    s_mov_b64 exec, 1
    ds_add_u32 v126, v127 offset:92
    s_mov_b64 exec, -1
    ds_read_b128 v[108:111], v123 offset:34080
    s_waitcnt lgkmcnt(5)
    v_mfma_f32_32x32x16_bf16 v[80:95], v[16:19], v[112:115], v[80:95]
    v_mul_f32 v70, 0xbfb8aa3b, v70
    v_mul_f32 v71, 0xbfb8aa3b, v71
    v_add_u32 v72, 0xa008000, v72
    ds_read_b128 v[112:115], v123 offset:34112
    v_mfma_f32_32x32x16_bf16 v[80:95], v[20:23], v[116:119], v[80:95]
    v_add_u32 v73, 0xa008000, v73
    v_add_u32 v74, 0xa008000, v74
    v_add_u32 v75, 0xa008000, v75
    ds_read_b128 v[116:119], v123 offset:34144
    s_waitcnt lgkmcnt(5)
    v_mfma_f32_32x32x16_bf16 v[80:95], v[24:27], v[96:99], v[80:95]
    v_add_u32 v76, 0xa008000, v76
    v_add_u32 v77, 0xa008000, v77
    v_add_u32 v78, 0xa008000, v78
    ds_read_b128 v[96:99], v123 offset:34176
    v_mfma_f32_32x32x16_bf16 v[80:95], v[28:31], v[100:103], v[80:95]
    v_add_u32 v79, 0xa008000, v79
    v_cvt_pk_bf16_f32 v64, v64, v65
    v_cvt_pk_bf16_f32 v66, v66, v67
    ds_read_b32 v122, v126 offset:92
    ds_read_b128 v[100:103], v123 offset:34208
    s_waitcnt lgkmcnt(5)
    v_mfma_f32_32x32x16_bf16 v[80:95], v[32:35], v[104:107], v[80:95]
    v_cvt_pk_bf16_f32 v68, v68, v69
    v_cvt_pk_bf16_f32 v70, v70, v71
    v_sub_u32_sdwa v72, v72, v64 dst_sel:DWORD dst_unused:UNUSED_PAD src0_sel:DWORD src1_sel:WORD_0
    ds_read_b128 v[104:107], v123 offset:34240
    v_mfma_f32_32x32x16_bf16 v[80:95], v[36:39], v[108:111], v[80:95]
    v_sub_u32_sdwa v73, v73, v64 dst_sel:DWORD dst_unused:UNUSED_PAD src0_sel:DWORD src1_sel:WORD_1
    v_sub_u32_sdwa v74, v74, v66 dst_sel:DWORD dst_unused:UNUSED_PAD src0_sel:DWORD src1_sel:WORD_0
    v_sub_u32_sdwa v75, v75, v66 dst_sel:DWORD dst_unused:UNUSED_PAD src0_sel:DWORD src1_sel:WORD_1
    ds_read_b128 v[108:111], v123 offset:34272
    s_waitcnt lgkmcnt(5)
    v_mfma_f32_32x32x16_bf16 v[80:95], v[40:43], v[112:115], v[80:95]
    v_sub_u32_sdwa v76, v76, v68 dst_sel:DWORD dst_unused:UNUSED_PAD src0_sel:DWORD src1_sel:WORD_0
    v_sub_u32_sdwa v77, v77, v68 dst_sel:DWORD dst_unused:UNUSED_PAD src0_sel:DWORD src1_sel:WORD_1
    v_sub_u32_sdwa v78, v78, v70 dst_sel:DWORD dst_unused:UNUSED_PAD src0_sel:DWORD src1_sel:WORD_0
    s_waitcnt lgkmcnt(3)
    v_readfirstlane_b32 s56, v122
sp15:
    s_and_b32 s56, s56, 0xf0f
    s_cmp_ge_u32 s56, 1028
    s_cbranch_scc1 sp15e
    s_sleep 1
sp15r:
    ds_read_b32 v122, v126 offset:92
    s_waitcnt lgkmcnt(0)
    v_readfirstlane_b32 s56, v122
    s_branch sp15
sp15e:
    ds_read_b128 v[112:115], v123 offset:50688
    v_mfma_f32_32x32x16_bf16 v[80:95], v[44:47], v[116:119], v[80:95]
    v_sub_u32_sdwa v79, v79, v70 dst_sel:DWORD dst_unused:UNUSED_PAD src0_sel:DWORD src1_sel:WORD_1
    v_perm_b32 v72, v72, v64, s59
    v_perm_b32 v73, v73, v64, s60
    ds_read_b128 v[116:119], v123 offset:50720
    s_waitcnt lgkmcnt(4)
    v_mfma_f32_32x32x16_bf16 v[80:95], v[48:51], v[96:99], v[80:95]
    v_perm_b32 v74, v74, v66, s59
    v_perm_b32 v75, v75, v66, s60
    v_perm_b32 v76, v76, v68, s59
    ds_read_b128 v[96:99], v123 offset:50752
    v_mfma_f32_32x32x16_bf16 v[80:95], v[52:55], v[100:103], v[80:95]
    v_perm_b32 v77, v77, v68, s60
    v_perm_b32 v78, v78, v70, s59
    v_perm_b32 v79, v79, v70, s60
    ds_read_b128 v[64:67], v125 offset:0
    ds_read_b128 v[68:71], v125 offset:4352
    ds_read_b128 v[100:103], v123 offset:50784
    s_waitcnt lgkmcnt(6)
    v_mfma_f32_32x32x16_bf16 v[80:95], v[56:59], v[104:107], v[80:95]
    ds_write_b128 v121, v[72:75] offset:0
    ds_write_b128 v121, v[76:79] offset:16
    v_add_u32 v121, 0x2200, v121
    ds_read_b128 v[104:107], v123 offset:50816
    v_mfma_f32_32x32x16_bf16 v[80:95], v[60:63], v[108:111], v[80:95]
    s_add_u32 s56, s65, 16384
    s_lshr_b32 s57, s56, 8
    s_and_b32 s57, s57, 0x2000
    s_xor_b32 s56, s56, s57
    s_add_u32 s57, s56, 4096
    s_waitcnt lgkmcnt(4)
    buffer_store_dwordx4 v[64:67], v120, s[52:55], s56 offen sc1
    buffer_store_dwordx4 v[68:71], v120, s[52:55], s57 offen sc1
    ds_read_b128 v[108:111], v123 offset:50848
    s_waitcnt lgkmcnt(8)
    v_mfma_f32_32x32x16_bf16 v[64:79], v[0:3], v[112:115], 0
    ds_read_b128 v[112:115], v123 offset:50880
    v_mfma_f32_32x32x16_bf16 v[64:79], v[4:7], v[116:119], v[64:79]
    ds_read_b128 v[116:119], v123 offset:50912
    s_waitcnt lgkmcnt(6)
    v_mfma_f32_32x32x16_bf16 v[64:79], v[8:11], v[96:99], v[64:79]
    s_nop 5
    v_mul_f32 v80, 0xbfb8aa3b, v80
    v_mul_f32 v81, 0xbfb8aa3b, v81
    v_mul_f32 v82, 0xbfb8aa3b, v82
    ds_read_b128 v[96:99], v123 offset:50944
    v_mfma_f32_32x32x16_bf16 v[64:79], v[12:15], v[100:103], v[64:79]
    v_mul_f32 v83, 0xbfb8aa3b, v83
    v_mul_f32 v84, 0xbfb8aa3b, v84
    v_mul_f32 v85, 0xbfb8aa3b, v85
    s_mov_b64 exec, 1
    ds_add_u32 v126, v127 offset:96
    s_mov_b64 exec, -1
    ds_read_b128 v[100:103], v123 offset:50976
    s_waitcnt lgkmcnt(5)
    v_mfma_f32_32x32x16_bf16 v[64:79], v[16:19], v[104:107], v[64:79]
    v_mul_f32 v86, 0xbfb8aa3b, v86
    v_mul_f32 v87, 0xbfb8aa3b, v87
    v_add_u32 v88, 0xa008000, v88
    ds_read_b128 v[104:107], v123 offset:51008
    v_mfma_f32_32x32x16_bf16 v[64:79], v[20:23], v[108:111], v[64:79]
    v_add_u32 v89, 0xa008000, v89
    v_add_u32 v90, 0xa008000, v90
    v_add_u32 v91, 0xa008000, v91
    ds_read_b128 v[108:111], v123 offset:51040
    s_waitcnt lgkmcnt(5)
    v_mfma_f32_32x32x16_bf16 v[64:79], v[24:27], v[112:115], v[64:79]
    v_add_u32 v92, 0xa008000, v92
    v_add_u32 v93, 0xa008000, v93
    v_add_u32 v94, 0xa008000, v94
    ds_read_b128 v[112:115], v123 offset:51072
    v_mfma_f32_32x32x16_bf16 v[64:79], v[28:31], v[116:119], v[64:79]
    v_add_u32 v95, 0xa008000, v95
    v_cvt_pk_bf16_f32 v80, v80, v81
    v_cvt_pk_bf16_f32 v82, v82, v83
    ds_read_b32 v122, v126 offset:96
    ds_read_b128 v[116:119], v123 offset:51104
    s_waitcnt lgkmcnt(5)
    v_mfma_f32_32x32x16_bf16 v[64:79], v[32:35], v[96:99], v[64:79]
    v_cvt_pk_bf16_f32 v84, v84, v85
    v_cvt_pk_bf16_f32 v86, v86, v87
    v_sub_u32_sdwa v88, v88, v80 dst_sel:DWORD dst_unused:UNUSED_PAD src0_sel:DWORD src1_sel:WORD_0
    ds_read_b128 v[96:99], v123 offset:51136
    v_mfma_f32_32x32x16_bf16 v[64:79], v[36:39], v[100:103], v[64:79]
    v_sub_u32_sdwa v89, v89, v80 dst_sel:DWORD dst_unused:UNUSED_PAD src0_sel:DWORD src1_sel:WORD_1
    v_sub_u32_sdwa v90, v90, v82 dst_sel:DWORD dst_unused:UNUSED_PAD src0_sel:DWORD src1_sel:WORD_0
    v_sub_u32_sdwa v91, v91, v82 dst_sel:DWORD dst_unused:UNUSED_PAD src0_sel:DWORD src1_sel:WORD_1
    ds_read_b128 v[100:103], v123 offset:51168
    s_waitcnt lgkmcnt(5)
    v_mfma_f32_32x32x16_bf16 v[64:79], v[40:43], v[104:107], v[64:79]
    v_sub_u32_sdwa v92, v92, v84 dst_sel:DWORD dst_unused:UNUSED_PAD src0_sel:DWORD src1_sel:WORD_0
    v_sub_u32_sdwa v93, v93, v84 dst_sel:DWORD dst_unused:UNUSED_PAD src0_sel:DWORD src1_sel:WORD_1
    v_sub_u32_sdwa v94, v94, v86 dst_sel:DWORD dst_unused:UNUSED_PAD src0_sel:DWORD src1_sel:WORD_0
    s_waitcnt lgkmcnt(3)
    v_readfirstlane_b32 s56, v122
sp16:
    s_and_b32 s56, s56, 0xf0f
    s_cmp_ge_u32 s56, 4
    s_cbranch_scc1 sp16e
    s_sleep 1
sp16r:
    ds_read_b32 v122, v126 offset:96
    s_waitcnt lgkmcnt(0)
    v_readfirstlane_b32 s56, v122
    s_branch sp16
sp16e:
    v_mfma_f32_32x32x16_bf16 v[64:79], v[44:47], v[108:111], v[64:79]
    v_sub_u32_sdwa v95, v95, v86 dst_sel:DWORD dst_unused:UNUSED_PAD src0_sel:DWORD src1_sel:WORD_1
    v_perm_b32 v88, v88, v80, s59
    v_perm_b32 v89, v89, v80, s60
    s_waitcnt lgkmcnt(2)
    v_mfma_f32_32x32x16_bf16 v[64:79], v[48:51], v[112:115], v[64:79]
    v_perm_b32 v90, v90, v82, s59
    v_perm_b32 v91, v91, v82, s60
    v_perm_b32 v92, v92, v84, s59
    v_mfma_f32_32x32x16_bf16 v[64:79], v[52:55], v[116:119], v[64:79]
    v_perm_b32 v93, v93, v84, s60
    v_perm_b32 v94, v94, v86, s59
    v_perm_b32 v95, v95, v86, s60
    ds_read_b128 v[80:83], v124 offset:0
    ds_read_b128 v[84:87], v124 offset:4352
    s_mov_b64 exec, 1
    ds_add_u32 v126, v127 offset:60
    s_mov_b64 exec, -1
    s_waitcnt lgkmcnt(3)
    v_mfma_f32_32x32x16_bf16 v[64:79], v[56:59], v[96:99], v[64:79]
    ds_write_b128 v121, v[88:91] offset:0
    ds_write_b128 v121, v[92:95] offset:16
    v_add_u32 v121, 0xffffde00, v121
    v_mfma_f32_32x32x16_bf16 v[64:79], v[60:63], v[100:103], v[64:79]
    s_add_u32 s56, s65, 32768
    s_lshr_b32 s57, s56, 8
    s_and_b32 s57, s57, 0x2000
    s_xor_b32 s56, s56, s57
    s_add_u32 s57, s56, 4096
    s_waitcnt lgkmcnt(3)
    buffer_store_dwordx4 v[80:83], v120, s[52:55], s56 offen sc1
    buffer_store_dwordx4 v[84:87], v120, s[52:55], s57 offen sc1
    ds_read_b32 v122, v126 offset:60
    s_nop 10
    v_mul_f32 v64, 0xbfb8aa3b, v64
    v_mul_f32 v65, 0xbfb8aa3b, v65
    v_mul_f32 v66, 0xbfb8aa3b, v66
    v_mul_f32 v67, 0xbfb8aa3b, v67
    v_mul_f32 v68, 0xbfb8aa3b, v68
    v_mul_f32 v69, 0xbfb8aa3b, v69
    v_mul_f32 v70, 0xbfb8aa3b, v70
    v_mul_f32 v71, 0xbfb8aa3b, v71
    v_add_u32 v72, 0xa008000, v72
    v_add_u32 v73, 0xa008000, v73
    v_add_u32 v74, 0xa008000, v74
    v_add_u32 v75, 0xa008000, v75
    v_add_u32 v76, 0xa008000, v76
    v_add_u32 v77, 0xa008000, v77
    v_add_u32 v78, 0xa008000, v78
    v_add_u32 v79, 0xa008000, v79
    v_cvt_pk_bf16_f32 v64, v64, v65
    v_cvt_pk_bf16_f32 v66, v66, v67
    v_cvt_pk_bf16_f32 v68, v68, v69
    v_cvt_pk_bf16_f32 v70, v70, v71
    v_sub_u32_sdwa v72, v72, v64 dst_sel:DWORD dst_unused:UNUSED_PAD src0_sel:DWORD src1_sel:WORD_0
    v_sub_u32_sdwa v73, v73, v64 dst_sel:DWORD dst_unused:UNUSED_PAD src0_sel:DWORD src1_sel:WORD_1
    v_sub_u32_sdwa v74, v74, v66 dst_sel:DWORD dst_unused:UNUSED_PAD src0_sel:DWORD src1_sel:WORD_0
    v_sub_u32_sdwa v75, v75, v66 dst_sel:DWORD dst_unused:UNUSED_PAD src0_sel:DWORD src1_sel:WORD_1
    v_sub_u32_sdwa v76, v76, v68 dst_sel:DWORD dst_unused:UNUSED_PAD src0_sel:DWORD src1_sel:WORD_0
    v_sub_u32_sdwa v77, v77, v68 dst_sel:DWORD dst_unused:UNUSED_PAD src0_sel:DWORD src1_sel:WORD_1
    v_sub_u32_sdwa v78, v78, v70 dst_sel:DWORD dst_unused:UNUSED_PAD src0_sel:DWORD src1_sel:WORD_0
    v_sub_u32_sdwa v79, v79, v70 dst_sel:DWORD dst_unused:UNUSED_PAD src0_sel:DWORD src1_sel:WORD_1
    v_perm_b32 v72, v72, v64, s59
    v_perm_b32 v73, v73, v64, s60
    v_perm_b32 v74, v74, v66, s59
    v_perm_b32 v75, v75, v66, s60
    v_perm_b32 v76, v76, v68, s59
    v_perm_b32 v77, v77, v68, s60
    v_perm_b32 v78, v78, v70, s59
    v_perm_b32 v79, v79, v70, s60
    s_waitcnt lgkmcnt(0)
    v_readfirstlane_b32 s56, v122
sp17:
    s_cmp_ge_u32 s56, 4
    s_cbranch_scc1 sp17e
sp17r:
    ds_read_b32 v122, v126 offset:60
    s_waitcnt lgkmcnt(0)
    v_readfirstlane_b32 s56, v122
    s_branch sp17
sp17e:
    ds_write_b128 v121, v[72:75] offset:0
    ds_write_b128 v121, v[76:79] offset:16
    s_mov_b64 exec, 1
    ds_add_rtn_u32 v122, v126, v127 offset:32
    s_mov_b64 exec, -1
    s_waitcnt lgkmcnt(0)
    v_readfirstlane_b32 s56, v122
    s_add_u32 s56, s56, 1
sp18:
    s_cmp_ge_u32 s56, 4
    s_cbranch_scc1 sp18e
sp18r:
    ds_read_b32 v122, v126 offset:32
    s_waitcnt lgkmcnt(0)
    v_readfirstlane_b32 s56, v122
    s_branch sp18
sp18e:
    ds_read_b128 v[104:107], v125 offset:0
    ds_read_b128 v[108:111], v125 offset:4352
    ds_read_b128 v[96:99], v124 offset:0
    ds_read_b128 v[100:103], v124 offset:4352
    s_add_u32 s56, s65, 49152
    s_lshr_b32 s57, s56, 8
    s_and_b32 s57, s57, 0x2000
    s_xor_b32 s56, s56, s57
    s_add_u32 s57, s56, 4096
    s_waitcnt lgkmcnt(2)
    buffer_store_dwordx4 v[104:107], v120, s[52:55], s56 offen sc1
    buffer_store_dwordx4 v[108:111], v120, s[52:55], s57 offen sc1
    s_add_u32 s56, s65, 65536
    s_lshr_b32 s57, s56, 8
    s_and_b32 s57, s57, 0x2000
    s_xor_b32 s56, s56, s57
    s_add_u32 s57, s56, 4096
    s_waitcnt lgkmcnt(0)
    buffer_store_dwordx4 v[96:99], v120, s[52:55], s56 offen sc1
    buffer_store_dwordx4 v[100:103], v120, s[52:55], s57 offen sc1
    s_mov_b64 exec, 1
    ds_add_u32 v126, v127 offset:52
    s_mov_b64 exec, -1
    s_setprio 3
    v_mbcnt_lo_u32_b32 v120, -1, 0
    v_mbcnt_hi_u32_b32 v120, -1, v120
    s_lshl_b32 s57, s3, 9
    s_add_u32 s57, s57, 0x1750000
    v_lshl_add_u32 v2, v120, 3, s57
    global_load_dwordx2 v[4:5], v2, s[22:23] sc1
    ds_read_b32 v13, v126 offset:72
    s_lshl_b32 s56, s3, 11
    s_add_u32 s56, s56, s68
    s_add_u32 s56, s56, s67
    s_add_u32 s48, s22, 0x3000000
    s_addc_u32 s49, s23, 0
    s_add_u32 s48, s48, s56
    s_addc_u32 s49, s49, 0
    s_or_b32 s49, s49, 0x100000
    s_mov_b32 s50, 0x170000
    s_mov_b32 s51, 0x20000
    v_and_b32 v3, 62, v120
    s_lshl_b32 s56, s3, 11
    s_add_u32 s56, s56, 148480
    v_add_u32 v3, s56, v3
    v_lshl_add_u32 v6, s3, 4, v126
    s_waitcnt lgkmcnt(0)
    v_readfirstlane_b32 s66, v13
    s_cmp_ge_u32 s66, 8
    s_cbranch_scc1 p_idx
    s_branch sp19r
sp19:
    s_cmp_ge_u32 s56, 1
    s_cbranch_scc1 sp19e
    s_sleep 1
sp19r:
    ds_read_b32 v122, v126 offset:8
    s_waitcnt lgkmcnt(0)
    v_readfirstlane_b32 s56, v122
    s_branch sp19
sp19e:
    ds_read_b64 v[0:1], v126 offset:104
    s_waitcnt vmcnt(0)
    s_mov_b64 exec, 1
    ds_add_rtn_u32 v122, v126, v127 offset:44
    s_mov_b64 exec, -1
    s_waitcnt lgkmcnt(0)
    v_readfirstlane_b32 s56, v122
    s_add_u32 s56, s56, 1
    s_cmp_lg_u32 s56, 4
    s_cbranch_scc1 p_pd0
    v_readfirstlane_b32 s18, v0
    v_readfirstlane_b32 s19, v1
    s_lshl_b32 s56, s25, 6
    s_add_u32 s56, s56, s24
    s_lshl_b32 s56, s56, 3
    s_add_u32 s56, s56, 0x1740000
    s_atomic_swap_x2 s[18:19], s[22:23], s56
    s_mov_b32 s56, 0
p_pd0:
    s_branch sp20r
sp20:
    s_cmp_ge_u32 s56, 8
    s_cbranch_scc1 sp20e
    s_sleep 1
sp20r:
    ds_read_b32 v122, v126 offset:72
    s_waitcnt lgkmcnt(0)
    v_readfirstlane_b32 s56, v122
    s_branch sp20
sp20e:
p_idx:
    ds_read_b64 v[0:1], v126 offset:104
    ds_read_b128 v[8:11], v6 offset:128
    ds_read_u16 v16, v3 offset:0
    ds_read_u16 v17, v3 offset:64
    ds_read_u16 v18, v3 offset:128
    ds_read_u16 v19, v3 offset:192
    ds_read_u16 v20, v3 offset:256
    ds_read_u16 v21, v3 offset:320
    ds_read_u16 v22, v3 offset:384
    ds_read_u16 v23, v3 offset:448
    ds_read_u16 v24, v3 offset:512
    ds_read_u16 v25, v3 offset:576
    ds_read_u16 v26, v3 offset:640
    ds_read_u16 v27, v3 offset:704
    ds_read_u16 v28, v3 offset:768
    ds_read_u16 v29, v3 offset:832
    ds_read_u16 v30, v3 offset:1024
    ds_read_u16 v31, v3 offset:1088
    ds_read_u16 v32, v3 offset:1152
    ds_read_u16 v33, v3 offset:1216
    ds_read_u16 v34, v3 offset:1280
    ds_read_u16 v35, v3 offset:1344
    ds_read_u16 v36, v3 offset:1408
    ds_read_u16 v37, v3 offset:1472
    ds_read_u16 v38, v3 offset:1536
    ds_read_u16 v39, v3 offset:1600
    ds_read_u16 v40, v3 offset:1664
    ds_read_u16 v41, v3 offset:1728
    ds_read_u16 v42, v3 offset:1792
    ds_read_u16 v43, v3 offset:1856
    s_mov_b64 exec, 1
    ds_add_u32 v126, v127 offset:76
    s_mov_b64 exec, -1
    s_waitcnt lgkmcnt(0)
    v_readfirstlane_b32 s60, v8
    v_readfirstlane_b32 s59, v9
    v_readfirstlane_b32 s62, v10
    v_readfirstlane_b32 s63, v11
    v_lshl_add_u32 v16, v16, 1, v120
    v_and_b32 v7, 0xffffffc0, v16
    v_mad_u32_u24 v16, v7, 15, v16
    v_lshl_add_u32 v17, v17, 1, v120
    v_and_b32 v7, 0xffffffc0, v17
    v_mad_u32_u24 v17, v7, 15, v17
    v_lshl_add_u32 v18, v18, 1, v120
    v_and_b32 v7, 0xffffffc0, v18
    v_mad_u32_u24 v18, v7, 15, v18
    v_lshl_add_u32 v19, v19, 1, v120
    v_and_b32 v7, 0xffffffc0, v19
    v_mad_u32_u24 v19, v7, 15, v19
    v_lshl_add_u32 v20, v20, 1, v120
    v_and_b32 v7, 0xffffffc0, v20
    v_mad_u32_u24 v20, v7, 15, v20
    v_lshl_add_u32 v21, v21, 1, v120
    v_and_b32 v7, 0xffffffc0, v21
    v_mad_u32_u24 v21, v7, 15, v21
    s_branch sp21r
sp21:
    s_cmp_ge_u32 s56, 4
    s_cbranch_scc1 sp21e
sp21r:
    ds_read_b32 v122, v126 offset:76
    s_waitcnt lgkmcnt(0)
    v_readfirstlane_b32 s56, v122
    s_branch sp21
sp21e:
    s_branch sp22r
sp22:
    s_and_b32 s56, s56, 0xf0
    s_cmp_ge_u32 s56, 64
    s_cbranch_scc1 sp22e
sp22r:
    ds_read_b32 v122, v126 offset:84
    s_waitcnt lgkmcnt(0)
    v_readfirstlane_b32 s56, v122
    s_branch sp22
sp22e:
    s_cmp_lt_u32 s66, 8
    s_cbranch_scc1 p_pd1
    s_waitcnt vmcnt(1)
    s_mov_b64 exec, 1
    ds_add_rtn_u32 v122, v126, v127 offset:44
    s_mov_b64 exec, -1
    s_waitcnt lgkmcnt(0)
    v_readfirstlane_b32 s56, v122
    s_add_u32 s56, s56, 1
    s_cmp_lg_u32 s56, 4
    s_cbranch_scc1 p_pd1
    v_readfirstlane_b32 s18, v0
    v_readfirstlane_b32 s19, v1
    s_lshl_b32 s56, s25, 6
    s_add_u32 s56, s56, s24
    s_lshl_b32 s56, s56, 3
    s_add_u32 s56, s56, 0x1740000
    s_atomic_swap_x2 s[18:19], s[22:23], s56
    s_mov_b32 s56, 0
p_pd1:
    s_mov_b32 s57, 262144
p_fp:
    s_waitcnt vmcnt(0)
    v_cmp_ne_u64 vcc, v[0:1], v[4:5]
    s_and_b64 exec, exec, vcc
    s_cbranch_scc0 p_fpe
    s_sleep 8
    global_load_dwordx2 v[4:5], v2, s[22:23] sc1
    s_sub_u32 s57, s57, 1
    s_cbranch_scc0 p_fp
p_fpe:
    s_mov_b64 exec, -1
    s_mul_i32 s58, s3, 12288
    s_add_u32 m0, s58, 114176
    s_mov_b32 s57, 0
    s_waitcnt vmcnt(11)
    buffer_load_dwordx4 v16, s[48:51], s57 idxen sc1 lds
    s_add_u32 m0, s58, 115200
    s_mov_b32 s57, 16384
    s_waitcnt vmcnt(11)
    buffer_load_dwordx4 v17, s[48:51], s57 idxen sc1 lds
    s_add_u32 m0, s58, 116224
    s_mov_b32 s57, 32768
    s_waitcnt vmcnt(11)
    buffer_load_dwordx4 v18, s[48:51], s57 idxen sc1 lds
    s_add_u32 m0, s58, 117248
    s_mov_b32 s57, 49152
    s_waitcnt vmcnt(11)
    buffer_load_dwordx4 v19, s[48:51], s57 idxen sc1 lds
    s_add_u32 m0, s58, 118272
    s_mov_b32 s57, 65536
    s_waitcnt vmcnt(11)
    buffer_load_dwordx4 v20, s[48:51], s57 idxen sc1 lds
    s_add_u32 m0, s58, 119296
    s_mov_b32 s57, 81920
    s_waitcnt vmcnt(11)
    buffer_load_dwordx4 v21, s[48:51], s57 idxen sc1 lds
    v_lshl_add_u32 v30, v30, 1, v120
    v_and_b32 v7, 0xffffffc0, v30
    v_mad_u32_u24 v30, v7, 15, v30
    s_add_u32 m0, s58, 120320
    s_mov_b32 s57, 1024
    s_waitcnt vmcnt(11)
    buffer_load_dwordx4 v30, s[48:51], s57 idxen sc1 lds
    v_lshl_add_u32 v31, v31, 1, v120
    v_and_b32 v7, 0xffffffc0, v31
    v_mad_u32_u24 v31, v7, 15, v31
    s_add_u32 m0, s58, 121344
    s_mov_b32 s57, 17408
    s_waitcnt vmcnt(11)
    buffer_load_dwordx4 v31, s[48:51], s57 idxen sc1 lds
    v_lshl_add_u32 v32, v32, 1, v120
    v_and_b32 v7, 0xffffffc0, v32
    v_mad_u32_u24 v32, v7, 15, v32
    s_add_u32 m0, s58, 122368
    s_mov_b32 s57, 33792
    s_waitcnt vmcnt(11)
    buffer_load_dwordx4 v32, s[48:51], s57 idxen sc1 lds
    v_lshl_add_u32 v33, v33, 1, v120
    v_and_b32 v7, 0xffffffc0, v33
    v_mad_u32_u24 v33, v7, 15, v33
    s_add_u32 m0, s58, 123392
    s_mov_b32 s57, 50176
    s_waitcnt vmcnt(11)
    buffer_load_dwordx4 v33, s[48:51], s57 idxen sc1 lds
    v_lshl_add_u32 v34, v34, 1, v120
    v_and_b32 v7, 0xffffffc0, v34
    v_mad_u32_u24 v34, v7, 15, v34
    s_add_u32 m0, s58, 124416
    s_mov_b32 s57, 66560
    s_waitcnt vmcnt(11)
    buffer_load_dwordx4 v34, s[48:51], s57 idxen sc1 lds
    v_lshl_add_u32 v35, v35, 1, v120
    v_and_b32 v7, 0xffffffc0, v35
    v_mad_u32_u24 v35, v7, 15, v35
    s_add_u32 m0, s58, 125440
    s_mov_b32 s57, 82944
    s_waitcnt vmcnt(11)
    buffer_load_dwordx4 v35, s[48:51], s57 idxen sc1 lds
    v_lshl_add_u32 v22, v22, 1, v120
    v_and_b32 v7, 0xffffffc0, v22
    v_mad_u32_u24 v22, v7, 15, v22
    v_lshl_add_u32 v23, v23, 1, v120
    v_and_b32 v7, 0xffffffc0, v23
    v_mad_u32_u24 v23, v7, 15, v23
    v_lshl_add_u32 v24, v24, 1, v120
    v_and_b32 v7, 0xffffffc0, v24
    v_mad_u32_u24 v24, v7, 15, v24
    v_lshl_add_u32 v25, v25, 1, v120
    v_and_b32 v7, 0xffffffc0, v25
    v_mad_u32_u24 v25, v7, 15, v25
    v_lshl_add_u32 v36, v36, 1, v120
    v_and_b32 v7, 0xffffffc0, v36
    v_mad_u32_u24 v36, v7, 15, v36
    v_lshl_add_u32 v37, v37, 1, v120
    v_and_b32 v7, 0xffffffc0, v37
    v_mad_u32_u24 v37, v7, 15, v37
    v_lshl_add_u32 v38, v38, 1, v120
    v_and_b32 v7, 0xffffffc0, v38
    v_mad_u32_u24 v38, v7, 15, v38
    v_lshl_add_u32 v39, v39, 1, v120
    v_and_b32 v7, 0xffffffc0, v39
    v_mad_u32_u24 v39, v7, 15, v39
    s_setprio 0
    v_lshlrev_b32 v123, 4, v120
    v_add_u32 v123, 100864, v123
    ds_read_b128 v[96:99], v123
    ds_read_b128 v[100:103], v123 offset:1024
    ds_read_b128 v[116:119], v123 offset:2048
    ds_read_b128 v[84:87], v123 offset:3072
    ds_read_b128 v[112:115], v123 offset:4096
    s_mov_b64 exec, 1
    ds_add_u32 v126, v127 offset:56
    s_mov_b64 exec, -1
    s_branch sp23r
sp23:
    s_cmp_ge_u32 s56, 8
    s_cbranch_scc1 sp23e
    s_sleep 2
sp23r:
    ds_read_b32 v122, v126 offset:56
    s_waitcnt lgkmcnt(0)
    v_readfirstlane_b32 s56, v122
    s_branch sp23
sp23e:
    s_setprio 3
    s_lshl_b32 s58, s60, 5
    s_cmp_gt_u32 s59, 192
    s_cbranch_scc0 p_ld0
    s_add_u32 m0, s58, 68096
    s_mov_b32 s56, 98304
    s_waitcnt vmcnt(11)
    buffer_load_dwordx4 v22, s[48:51], s56 idxen sc1 lds
    s_cmp_gt_u32 s59, 224
    s_cbranch_scc0 p_ld0
    s_add_u32 m0, s58, 69120
    s_mov_b32 s56, 114688
    s_waitcnt vmcnt(11)
    buffer_load_dwordx4 v23, s[48:51], s56 idxen sc1 lds
    s_cmp_gt_u32 s59, 256
    s_cbranch_scc0 p_ld0
    s_add_u32 m0, s58, 70144
    s_mov_b32 s56, 131072
    s_waitcnt vmcnt(11)
    buffer_load_dwordx4 v24, s[48:51], s56 idxen sc1 lds
    s_cmp_gt_u32 s59, 288
    s_cbranch_scc0 p_ld0
    s_add_u32 m0, s58, 71168
    s_mov_b32 s56, 147456
    s_waitcnt vmcnt(11)
    buffer_load_dwordx4 v25, s[48:51], s56 idxen sc1 lds
    s_cmp_gt_u32 s59, 320
    s_cbranch_scc0 p_ld0
    v_lshl_add_u32 v26, v26, 1, v120
    v_and_b32 v7, 0xffffffc0, v26
    v_mad_u32_u24 v26, v7, 15, v26
    s_add_u32 m0, s58, 72192
    s_mov_b32 s56, 163840
    s_waitcnt vmcnt(11)
    buffer_load_dwordx4 v26, s[48:51], s56 idxen sc1 lds
    s_cmp_gt_u32 s59, 352
    s_cbranch_scc0 p_ld0
    v_lshl_add_u32 v27, v27, 1, v120
    v_and_b32 v7, 0xffffffc0, v27
    v_mad_u32_u24 v27, v7, 15, v27
    s_add_u32 m0, s58, 73216
    s_mov_b32 s56, 180224
    s_waitcnt vmcnt(11)
    buffer_load_dwordx4 v27, s[48:51], s56 idxen sc1 lds
    s_cmp_gt_u32 s59, 384
    s_cbranch_scc0 p_ld0
    v_lshl_add_u32 v28, v28, 1, v120
    v_and_b32 v7, 0xffffffc0, v28
    v_mad_u32_u24 v28, v7, 15, v28
    s_add_u32 m0, s58, 74240
    s_mov_b32 s56, 196608
    s_waitcnt vmcnt(11)
    buffer_load_dwordx4 v28, s[48:51], s56 idxen sc1 lds
    s_cmp_gt_u32 s59, 416
    s_cbranch_scc0 p_ld0
    v_lshl_add_u32 v29, v29, 1, v120
    v_and_b32 v7, 0xffffffc0, v29
    v_mad_u32_u24 v29, v7, 15, v29
    s_add_u32 m0, s58, 75264
    s_mov_b32 s56, 212992
    s_waitcnt vmcnt(11)
    buffer_load_dwordx4 v29, s[48:51], s56 idxen sc1 lds
p_ld0:
    s_lshl_b32 s58, s62, 5
    s_cmp_gt_u32 s63, 192
    s_cbranch_scc0 p_ld1
    s_add_u32 m0, s58, 68096
    s_mov_b32 s56, 99328
    s_waitcnt vmcnt(11)
    buffer_load_dwordx4 v36, s[48:51], s56 idxen sc1 lds
    s_cmp_gt_u32 s63, 224
    s_cbranch_scc0 p_ld1
    s_add_u32 m0, s58, 69120
    s_mov_b32 s56, 115712
    s_waitcnt vmcnt(11)
    buffer_load_dwordx4 v37, s[48:51], s56 idxen sc1 lds
    s_cmp_gt_u32 s63, 256
    s_cbranch_scc0 p_ld1
    s_add_u32 m0, s58, 70144
    s_mov_b32 s56, 132096
    s_waitcnt vmcnt(11)
    buffer_load_dwordx4 v38, s[48:51], s56 idxen sc1 lds
    s_cmp_gt_u32 s63, 288
    s_cbranch_scc0 p_ld1
    s_add_u32 m0, s58, 71168
    s_mov_b32 s56, 148480
    s_waitcnt vmcnt(11)
    buffer_load_dwordx4 v39, s[48:51], s56 idxen sc1 lds
    s_cmp_gt_u32 s63, 320
    s_cbranch_scc0 p_ld1
    v_lshl_add_u32 v40, v40, 1, v120
    v_and_b32 v7, 0xffffffc0, v40
    v_mad_u32_u24 v40, v7, 15, v40
    s_add_u32 m0, s58, 72192
    s_mov_b32 s56, 164864
    s_waitcnt vmcnt(11)
    buffer_load_dwordx4 v40, s[48:51], s56 idxen sc1 lds
    s_cmp_gt_u32 s63, 352
    s_cbranch_scc0 p_ld1
    v_lshl_add_u32 v41, v41, 1, v120
    v_and_b32 v7, 0xffffffc0, v41
    v_mad_u32_u24 v41, v7, 15, v41
    s_add_u32 m0, s58, 73216
    s_mov_b32 s56, 181248
    s_waitcnt vmcnt(11)
    buffer_load_dwordx4 v41, s[48:51], s56 idxen sc1 lds
    s_cmp_gt_u32 s63, 384
    s_cbranch_scc0 p_ld1
    v_lshl_add_u32 v42, v42, 1, v120
    v_and_b32 v7, 0xffffffc0, v42
    v_mad_u32_u24 v42, v7, 15, v42
    s_add_u32 m0, s58, 74240
    s_mov_b32 s56, 197632
    s_waitcnt vmcnt(11)
    buffer_load_dwordx4 v42, s[48:51], s56 idxen sc1 lds
    s_cmp_gt_u32 s63, 416
    s_cbranch_scc0 p_ld1
    v_lshl_add_u32 v43, v43, 1, v120
    v_and_b32 v7, 0xffffffc0, v43
    v_mad_u32_u24 v43, v7, 15, v43
    s_add_u32 m0, s58, 75264
    s_mov_b32 s56, 214016
    s_waitcnt vmcnt(11)
    buffer_load_dwordx4 v43, s[48:51], s56 idxen sc1 lds
p_ld1:
    v_mov_b32 v3, 0x1000
    s_mov_b64 exec, 1
    ds_add_u32 v126, v3 offset:68
    s_mov_b64 exec, -1
    s_waitcnt vmcnt(0)
    s_mov_b64 exec, 1
    ds_add_u32 v126, v127 offset:112
    s_mov_b64 exec, -1
    s_branch k_join
a_role:
    v_mov_b32 v124, 0x100
    s_add_u32 m0, s62, 33280
    s_add_u32 s57, s63, 16384
    buffer_load_dwordx4 v125, s[36:39], s57 offen lds
    s_add_u32 m0, s62, 37504
    s_add_u32 s57, s63, 20480
    buffer_load_dwordx4 v125, s[36:39], s57 offen lds
    s_add_u32 m0, s62, 41728
    s_add_u32 s57, s63, 24576
    buffer_load_dwordx4 v125, s[36:39], s57 offen lds
    s_add_u32 m0, s62, 45952
    s_add_u32 s57, s63, 28672
    buffer_load_dwordx4 v125, s[36:39], s57 offen lds
    s_add_u32 m0, s62, 50176
    s_add_u32 s57, s63, 32768
    buffer_load_dwordx4 v125, s[36:39], s57 offen lds
    s_add_u32 m0, s62, 54400
    s_add_u32 s57, s63, 36864
    buffer_load_dwordx4 v125, s[36:39], s57 offen lds
    s_add_u32 m0, s62, 58624
    s_add_u32 s57, s63, 40960
    buffer_load_dwordx4 v125, s[36:39], s57 offen lds
    s_add_u32 m0, s62, 62848
    s_add_u32 s57, s63, 45056
    buffer_load_dwordx4 v125, s[36:39], s57 offen lds
    s_mov_b64 exec, 1
    ds_add_u32 v126, v127 offset:64
    s_mov_b64 exec, -1
    v_mov_b32 v127, 16
    s_setprio 1
    ds_read_b128 v[96:99], v123 offset:0
    ds_read_b128 v[100:103], v123 offset:32
    ds_read_b128 v[104:107], v123 offset:64
    ds_read_b128 v[108:111], v123 offset:96
    ds_read_b128 v[112:115], v123 offset:128
    ds_read_b128 v[116:119], v123 offset:160
    s_waitcnt lgkmcnt(4)
    v_mfma_f32_32x32x16_bf16 v[64:79], v[0:3], v[96:99], 0
    ds_read_b128 v[96:99], v123 offset:192
    v_mfma_f32_32x32x16_bf16 v[64:79], v[4:7], v[100:103], v[64:79]
    ds_read_b128 v[100:103], v123 offset:224
    s_waitcnt lgkmcnt(4)
    v_mfma_f32_32x32x16_bf16 v[64:79], v[8:11], v[104:107], v[64:79]
    s_waitcnt vmcnt(4)
    s_mov_b64 exec, 1
    ds_add_u32 v126, v124 offset:80
    s_mov_b64 exec, -1
    s_add_u32 m0, s62, 67072
    s_add_u32 s57, s63, 49152
    buffer_load_dwordx4 v125, s[36:39], s57 offen lds
    s_add_u32 m0, s62, 71296
    s_add_u32 s57, s63, 53248
    buffer_load_dwordx4 v125, s[36:39], s57 offen lds
    s_add_u32 m0, s62, 75520
    s_add_u32 s57, s63, 57344
    buffer_load_dwordx4 v125, s[36:39], s57 offen lds
    s_add_u32 m0, s62, 79744
    s_add_u32 s57, s63, 61440
    buffer_load_dwordx4 v125, s[36:39], s57 offen lds
    ds_read_b128 v[104:107], v123 offset:256
    v_mfma_f32_32x32x16_bf16 v[64:79], v[12:15], v[108:111], v[64:79]
    s_mov_b64 exec, 1
    ds_add_u32 v126, v127 offset:80
    s_mov_b64 exec, -1
    ds_read_b128 v[108:111], v123 offset:288
    s_waitcnt lgkmcnt(6)
    v_mfma_f32_32x32x16_bf16 v[64:79], v[16:19], v[112:115], v[64:79]
    ds_read_b128 v[112:115], v123 offset:320
    v_mfma_f32_32x32x16_bf16 v[64:79], v[20:23], v[116:119], v[64:79]
    ds_read_b128 v[116:119], v123 offset:352
    s_waitcnt lgkmcnt(6)
    v_mfma_f32_32x32x16_bf16 v[64:79], v[24:27], v[96:99], v[64:79]
    ds_read_b128 v[96:99], v123 offset:384
    v_mfma_f32_32x32x16_bf16 v[64:79], v[28:31], v[100:103], v[64:79]
    ds_read_b32 v122, v126 offset:80
    ds_read_b128 v[100:103], v123 offset:416
    s_waitcnt lgkmcnt(5)
    v_mfma_f32_32x32x16_bf16 v[64:79], v[32:35], v[104:107], v[64:79]
    ds_read_b128 v[104:107], v123 offset:448
    v_mfma_f32_32x32x16_bf16 v[64:79], v[36:39], v[108:111], v[64:79]
    s_waitcnt vmcnt(4)
    s_mov_b64 exec, 1
    ds_add_u32 v126, v124 offset:84
    s_mov_b64 exec, -1
    s_add_u32 m0, s62, 83968
    s_add_u32 s57, s63, 65536
    buffer_load_dwordx4 v125, s[36:39], s57 offen lds
    s_add_u32 m0, s62, 88192
    s_add_u32 s57, s63, 69632
    buffer_load_dwordx4 v125, s[36:39], s57 offen lds
    s_add_u32 m0, s62, 92416
    s_add_u32 s57, s63, 73728
    buffer_load_dwordx4 v125, s[36:39], s57 offen lds
    s_add_u32 m0, s62, 96640
    s_add_u32 s57, s63, 77824
    buffer_load_dwordx4 v125, s[36:39], s57 offen lds
    ds_read_b128 v[108:111], v123 offset:480
    s_waitcnt lgkmcnt(6)
    v_mfma_f32_32x32x16_bf16 v[64:79], v[40:43], v[112:115], v[64:79]
    s_waitcnt lgkmcnt(4)
    v_readfirstlane_b32 s56, v122
sp24:
    s_and_b32 s56, s56, 0xf00
    s_cmp_ge_u32 s56, 1024
    s_cbranch_scc1 sp24e
    s_sleep 1
sp24r:
    ds_read_b32 v122, v126 offset:80
    s_waitcnt lgkmcnt(0)
    v_readfirstlane_b32 s56, v122
    s_branch sp24
sp24e:
    v_add_u32 v123, 0xfffe8200, v123
    ds_read_b128 v[112:115], v123 offset:0
    v_mfma_f32_32x32x16_bf16 v[64:79], v[44:47], v[116:119], v[64:79]
    ds_read_b128 v[116:119], v123 offset:32
    s_waitcnt lgkmcnt(5)
    v_mfma_f32_32x32x16_bf16 v[64:79], v[48:51], v[96:99], v[64:79]
    ds_read_b128 v[96:99], v123 offset:64
    v_mfma_f32_32x32x16_bf16 v[64:79], v[52:55], v[100:103], v[64:79]
    ds_read_b128 v[100:103], v123 offset:96
    s_waitcnt lgkmcnt(4)
    v_mfma_f32_32x32x16_bf16 v[64:79], v[56:59], v[104:107], v[64:79]
    ds_read_b128 v[104:107], v123 offset:128
    v_mfma_f32_32x32x16_bf16 v[64:79], v[60:63], v[108:111], v[64:79]
    ds_read_b128 v[108:111], v123 offset:160
    s_waitcnt lgkmcnt(4)
    v_mfma_f32_32x32x16_bf16 v[80:95], v[0:3], v[112:115], 0
    ds_read_b128 v[112:115], v123 offset:192
    v_mfma_f32_32x32x16_bf16 v[80:95], v[4:7], v[116:119], v[80:95]
    s_waitcnt vmcnt(4)
    s_mov_b64 exec, 1
    ds_add_u32 v126, v124 offset:88
    s_mov_b64 exec, -1
    ds_read_b128 v[116:119], v123 offset:224
    s_waitcnt lgkmcnt(5)
    v_mfma_f32_32x32x16_bf16 v[80:95], v[8:11], v[96:99], v[80:95]
    s_nop 5
    v_mul_f32 v64, 0xbfb8aa3b, v64
    v_mul_f32 v65, 0xbfb8aa3b, v65
    ds_read_b128 v[96:99], v123 offset:256
    v_mfma_f32_32x32x16_bf16 v[80:95], v[12:15], v[100:103], v[80:95]
    v_mul_f32 v66, 0xbfb8aa3b, v66
    v_mul_f32 v67, 0xbfb8aa3b, v67
    s_mov_b64 exec, 1
    ds_add_u32 v126, v127 offset:84
    s_mov_b64 exec, -1
    ds_read_b128 v[100:103], v123 offset:288
    s_waitcnt lgkmcnt(6)
    v_mfma_f32_32x32x16_bf16 v[80:95], v[16:19], v[104:107], v[80:95]
    v_mul_f32 v68, 0xbfb8aa3b, v68
    v_mul_f32 v69, 0xbfb8aa3b, v69
    ds_read_b128 v[104:107], v123 offset:320
    v_mfma_f32_32x32x16_bf16 v[80:95], v[20:23], v[108:111], v[80:95]
    v_mul_f32 v70, 0xbfb8aa3b, v70
    v_mul_f32 v71, 0xbfb8aa3b, v71
    ds_read_b128 v[108:111], v123 offset:352
    s_waitcnt lgkmcnt(5)
    v_mfma_f32_32x32x16_bf16 v[80:95], v[24:27], v[112:115], v[80:95]
    v_mul_f32 v72, 0x49800000, v72
    v_mul_f32 v73, 0x49800000, v73
    ds_read_b128 v[112:115], v123 offset:384
    v_mfma_f32_32x32x16_bf16 v[80:95], v[28:31], v[116:119], v[80:95]
    v_mul_f32 v74, 0x49800000, v74
    v_mul_f32 v75, 0x49800000, v75
    ds_read_b32 v122, v126 offset:84
    ds_read_b128 v[116:119], v123 offset:416
    s_waitcnt lgkmcnt(5)
    v_mfma_f32_32x32x16_bf16 v[80:95], v[32:35], v[96:99], v[80:95]
    v_mul_f32 v76, 0x49800000, v76
    v_mul_f32 v77, 0x49800000, v77
    ds_read_b128 v[96:99], v123 offset:448
    v_mfma_f32_32x32x16_bf16 v[80:95], v[36:39], v[100:103], v[80:95]
    v_mul_f32 v78, 0x49800000, v78
    v_mul_f32 v79, 0x49800000, v79
    s_waitcnt vmcnt(0)
    s_mov_b64 exec, 1
    ds_add_u32 v126, v124 offset:92
    s_mov_b64 exec, -1
    ds_read_b128 v[100:103], v123 offset:480
    s_waitcnt lgkmcnt(6)
    v_mfma_f32_32x32x16_bf16 v[80:95], v[40:43], v[104:107], v[80:95]
    v_cvt_pk_bf16_f32 v72, v64, v72
    v_cvt_pk_bf16_f32 v73, v65, v73
    s_waitcnt lgkmcnt(4)
    v_readfirstlane_b32 s56, v122
sp25:
    s_and_b32 s56, s56, 0xf00
    s_cmp_ge_u32 s56, 1024
    s_cbranch_scc1 sp25e
    s_sleep 1
sp25r:
    ds_read_b32 v122, v126 offset:84
    s_waitcnt lgkmcnt(0)
    v_readfirstlane_b32 s56, v122
    s_branch sp25
sp25e:
    ds_read_b128 v[104:107], v123 offset:16896
    v_mfma_f32_32x32x16_bf16 v[80:95], v[44:47], v[108:111], v[80:95]
    v_cvt_pk_bf16_f32 v74, v66, v74
    v_cvt_pk_bf16_f32 v75, v67, v75
    ds_read_b128 v[108:111], v123 offset:16928
    s_waitcnt lgkmcnt(5)
    v_mfma_f32_32x32x16_bf16 v[80:95], v[48:51], v[112:115], v[80:95]
    v_cvt_pk_bf16_f32 v76, v68, v76
    v_cvt_pk_bf16_f32 v77, v69, v77
    ds_read_b128 v[112:115], v123 offset:16960
    v_mfma_f32_32x32x16_bf16 v[80:95], v[52:55], v[116:119], v[80:95]
    v_cvt_pk_bf16_f32 v78, v70, v78
    v_cvt_pk_bf16_f32 v79, v71, v79
    s_branch sp26r
sp26:
    s_and_b32 s56, s56, 0xf
    s_cmp_ge_u32 s56, 4
    s_cbranch_scc1 sp26e
    s_sleep 1
sp26r:
    ds_read_b32 v120, v126 offset:60
    s_waitcnt lgkmcnt(0)
    v_readfirstlane_b32 s56, v120
    s_branch sp26
sp26e:
    ds_read_b128 v[116:119], v123 offset:16992
    s_waitcnt lgkmcnt(4)
    v_mfma_f32_32x32x16_bf16 v[80:95], v[56:59], v[96:99], v[80:95]
    ds_write_b128 v121, v[72:75] offset:0
    ds_write_b128 v121, v[76:79] offset:16
    v_add_u32 v121, 0x2200, v121
    s_branch sp27r
sp27:
    s_cmp_ge_u32 s56, 8
    s_cbranch_scc1 sp27e
    s_sleep 1
sp27r:
    ds_read_b32 v120, v126 offset:12
    s_waitcnt lgkmcnt(0)
    v_readfirstlane_b32 s56, v120
    s_branch sp27
sp27e:
    ds_read_b128 v[96:99], v123 offset:17024
    v_mfma_f32_32x32x16_bf16 v[80:95], v[60:63], v[100:103], v[80:95]
    ds_read_b128 v[100:103], v123 offset:17056
    s_waitcnt lgkmcnt(6)
    v_mfma_f32_32x32x16_bf16 v[64:79], v[0:3], v[104:107], 0
    ds_read_b128 v[104:107], v123 offset:17088
    v_mfma_f32_32x32x16_bf16 v[64:79], v[4:7], v[108:111], v[64:79]
    ds_read_b128 v[108:111], v123 offset:17120
    s_waitcnt lgkmcnt(6)
    v_mfma_f32_32x32x16_bf16 v[64:79], v[8:11], v[112:115], v[64:79]
    s_nop 5
    v_mul_f32 v80, 0xbfb8aa3b, v80
    v_mul_f32 v81, 0xbfb8aa3b, v81
    ds_read_b128 v[112:115], v123 offset:17152
    v_mfma_f32_32x32x16_bf16 v[64:79], v[12:15], v[116:119], v[64:79]
    v_mul_f32 v82, 0xbfb8aa3b, v82
    v_mul_f32 v83, 0xbfb8aa3b, v83
    s_mov_b64 exec, 1
    ds_add_u32 v126, v127 offset:88
    s_mov_b64 exec, -1
    ds_read_b128 v[116:119], v123 offset:17184
    s_waitcnt lgkmcnt(5)
    v_mfma_f32_32x32x16_bf16 v[64:79], v[16:19], v[96:99], v[64:79]
    v_mul_f32 v84, 0xbfb8aa3b, v84
    v_mul_f32 v85, 0xbfb8aa3b, v85
    ds_read_b128 v[96:99], v123 offset:17216
    v_mfma_f32_32x32x16_bf16 v[64:79], v[20:23], v[100:103], v[64:79]
    v_mul_f32 v86, 0xbfb8aa3b, v86
    v_mul_f32 v87, 0xbfb8aa3b, v87
    ds_read_b128 v[100:103], v123 offset:17248
    s_waitcnt lgkmcnt(5)
    v_mfma_f32_32x32x16_bf16 v[64:79], v[24:27], v[104:107], v[64:79]
    v_mul_f32 v88, 0x49800000, v88
    v_mul_f32 v89, 0x49800000, v89
    ds_read_b128 v[104:107], v123 offset:17280
    v_mfma_f32_32x32x16_bf16 v[64:79], v[28:31], v[108:111], v[64:79]
    v_mul_f32 v90, 0x49800000, v90
    v_mul_f32 v91, 0x49800000, v91
    ds_read_b32 v122, v126 offset:88
    ds_read_b128 v[108:111], v123 offset:17312
    s_waitcnt lgkmcnt(5)
    v_mfma_f32_32x32x16_bf16 v[64:79], v[32:35], v[112:115], v[64:79]
    v_mul_f32 v92, 0x49800000, v92
    v_mul_f32 v93, 0x49800000, v93
    ds_read_b128 v[112:115], v123 offset:17344
    v_mfma_f32_32x32x16_bf16 v[64:79], v[36:39], v[116:119], v[64:79]
    v_mul_f32 v94, 0x49800000, v94
    v_mul_f32 v95, 0x49800000, v95
    ds_read_b128 v[116:119], v123 offset:17376
    s_waitcnt lgkmcnt(5)
    v_mfma_f32_32x32x16_bf16 v[64:79], v[40:43], v[96:99], v[64:79]
    v_cvt_pk_bf16_f32 v88, v80, v88
    v_cvt_pk_bf16_f32 v89, v81, v89
    s_waitcnt lgkmcnt(3)
    v_readfirstlane_b32 s56, v122
sp28:
    s_and_b32 s56, s56, 0xfff
    s_cmp_ge_u32 s56, 1092
    s_cbranch_scc1 sp28e
    s_sleep 1
sp28r:
    ds_read_b32 v122, v126 offset:88
    s_waitcnt lgkmcnt(0)
    v_readfirstlane_b32 s56, v122
    s_branch sp28
sp28e:
    ds_read_b128 v[96:99], v123 offset:33792
    v_mfma_f32_32x32x16_bf16 v[64:79], v[44:47], v[100:103], v[64:79]
    v_cvt_pk_bf16_f32 v90, v82, v90
    v_cvt_pk_bf16_f32 v91, v83, v91
    ds_read_b128 v[100:103], v123 offset:33824
    s_waitcnt lgkmcnt(4)
    v_mfma_f32_32x32x16_bf16 v[64:79], v[48:51], v[104:107], v[64:79]
    v_cvt_pk_bf16_f32 v92, v84, v92
    v_cvt_pk_bf16_f32 v93, v85, v93
    ds_read_b128 v[104:107], v123 offset:33856
    v_mfma_f32_32x32x16_bf16 v[64:79], v[52:55], v[108:111], v[64:79]
    v_cvt_pk_bf16_f32 v94, v86, v94
    v_cvt_pk_bf16_f32 v95, v87, v95
    ds_read_b128 v[108:111], v123 offset:33888
    s_waitcnt lgkmcnt(4)
    v_mfma_f32_32x32x16_bf16 v[64:79], v[56:59], v[112:115], v[64:79]
    ds_write_b128 v121, v[88:91] offset:0
    ds_write_b128 v121, v[92:95] offset:16
    v_add_u32 v121, 0x2200, v121
    ds_read_b128 v[112:115], v123 offset:33920
    v_mfma_f32_32x32x16_bf16 v[64:79], v[60:63], v[116:119], v[64:79]
    ds_read_b128 v[116:119], v123 offset:33952
    s_waitcnt lgkmcnt(6)
    v_mfma_f32_32x32x16_bf16 v[80:95], v[0:3], v[96:99], 0
    ds_read_b128 v[96:99], v123 offset:33984
    v_mfma_f32_32x32x16_bf16 v[80:95], v[4:7], v[100:103], v[80:95]
    ds_read_b128 v[100:103], v123 offset:34016
    s_waitcnt lgkmcnt(6)
    v_mfma_f32_32x32x16_bf16 v[80:95], v[8:11], v[104:107], v[80:95]
    s_nop 5
    v_mul_f32 v64, 0xbfb8aa3b, v64
    v_mul_f32 v65, 0xbfb8aa3b, v65
    ds_read_b128 v[104:107], v123 offset:34048
    v_mfma_f32_32x32x16_bf16 v[80:95], v[12:15], v[108:111], v[80:95]
    v_mul_f32 v66, 0xbfb8aa3b, v66
    v_mul_f32 v67, 0xbfb8aa3b, v67
    s_mov_b64 exec, 1
    ds_add_u32 v126, v127 offset:92
    s_mov_b64 exec, -1
    ds_read_b128 v[108:111], v123 offset:34080
    s_waitcnt lgkmcnt(5)
    v_mfma_f32_32x32x16_bf16 v[80:95], v[16:19], v[112:115], v[80:95]
    v_mul_f32 v68, 0xbfb8aa3b, v68
    v_mul_f32 v69, 0xbfb8aa3b, v69
    ds_read_b128 v[112:115], v123 offset:34112
    v_mfma_f32_32x32x16_bf16 v[80:95], v[20:23], v[116:119], v[80:95]
    v_mul_f32 v70, 0xbfb8aa3b, v70
    v_mul_f32 v71, 0xbfb8aa3b, v71
    ds_read_b128 v[116:119], v123 offset:34144
    s_waitcnt lgkmcnt(5)
    v_mfma_f32_32x32x16_bf16 v[80:95], v[24:27], v[96:99], v[80:95]
    v_mul_f32 v72, 0x49800000, v72
    v_mul_f32 v73, 0x49800000, v73
    ds_read_b128 v[96:99], v123 offset:34176
    v_mfma_f32_32x32x16_bf16 v[80:95], v[28:31], v[100:103], v[80:95]
    v_mul_f32 v74, 0x49800000, v74
    v_mul_f32 v75, 0x49800000, v75
    ds_read_b32 v122, v126 offset:92
    ds_read_b128 v[100:103], v123 offset:34208
    s_waitcnt lgkmcnt(5)
    v_mfma_f32_32x32x16_bf16 v[80:95], v[32:35], v[104:107], v[80:95]
    v_mul_f32 v76, 0x49800000, v76
    v_mul_f32 v77, 0x49800000, v77
    ds_read_b128 v[104:107], v123 offset:34240
    v_mfma_f32_32x32x16_bf16 v[80:95], v[36:39], v[108:111], v[80:95]
    v_mul_f32 v78, 0x49800000, v78
    v_mul_f32 v79, 0x49800000, v79
    ds_read_b128 v[108:111], v123 offset:34272
    s_waitcnt lgkmcnt(5)
    v_mfma_f32_32x32x16_bf16 v[80:95], v[40:43], v[112:115], v[80:95]
    v_cvt_pk_bf16_f32 v72, v64, v72
    v_cvt_pk_bf16_f32 v73, v65, v73
    s_waitcnt lgkmcnt(3)
    v_readfirstlane_b32 s56, v122
sp29:
    s_and_b32 s56, s56, 0xfff
    s_cmp_ge_u32 s56, 1092
    s_cbranch_scc1 sp29e
    s_sleep 1
sp29r:
    ds_read_b32 v122, v126 offset:92
    s_waitcnt lgkmcnt(0)
    v_readfirstlane_b32 s56, v122
    s_branch sp29
sp29e:
    ds_read_b128 v[112:115], v123 offset:50688
    v_mfma_f32_32x32x16_bf16 v[80:95], v[44:47], v[116:119], v[80:95]
    v_cvt_pk_bf16_f32 v74, v66, v74
    v_cvt_pk_bf16_f32 v75, v67, v75
    ds_read_b128 v[116:119], v123 offset:50720
    s_waitcnt lgkmcnt(4)
    v_mfma_f32_32x32x16_bf16 v[80:95], v[48:51], v[96:99], v[80:95]
    v_cvt_pk_bf16_f32 v76, v68, v76
    v_cvt_pk_bf16_f32 v77, v69, v77
    ds_read_b128 v[96:99], v123 offset:50752
    v_mfma_f32_32x32x16_bf16 v[80:95], v[52:55], v[100:103], v[80:95]
    v_cvt_pk_bf16_f32 v78, v70, v78
    v_cvt_pk_bf16_f32 v79, v71, v79
    ds_read_b128 v[100:103], v123 offset:50784
    s_waitcnt lgkmcnt(4)
    v_mfma_f32_32x32x16_bf16 v[80:95], v[56:59], v[104:107], v[80:95]
    ds_write_b128 v121, v[72:75] offset:0
    ds_write_b128 v121, v[76:79] offset:16
    v_add_u32 v121, 0x2200, v121
    ds_read_b128 v[104:107], v123 offset:50816
    v_mfma_f32_32x32x16_bf16 v[80:95], v[60:63], v[108:111], v[80:95]
    ds_read_b128 v[108:111], v123 offset:50848
    s_waitcnt lgkmcnt(6)
    v_mfma_f32_32x32x16_bf16 v[64:79], v[0:3], v[112:115], 0
    ds_read_b128 v[112:115], v123 offset:50880
    v_mfma_f32_32x32x16_bf16 v[64:79], v[4:7], v[116:119], v[64:79]
    ds_read_b128 v[116:119], v123 offset:50912
    s_waitcnt lgkmcnt(6)
    v_mfma_f32_32x32x16_bf16 v[64:79], v[8:11], v[96:99], v[64:79]
    s_nop 5
    v_mul_f32 v80, 0xbfb8aa3b, v80
    v_mul_f32 v81, 0xbfb8aa3b, v81
    ds_read_b128 v[96:99], v123 offset:50944
    v_mfma_f32_32x32x16_bf16 v[64:79], v[12:15], v[100:103], v[64:79]
    v_mul_f32 v82, 0xbfb8aa3b, v82
    v_mul_f32 v83, 0xbfb8aa3b, v83
    s_mov_b64 exec, 1
    ds_add_u32 v126, v127 offset:96
    s_mov_b64 exec, -1
    ds_read_b128 v[100:103], v123 offset:50976
    s_waitcnt lgkmcnt(5)
    v_mfma_f32_32x32x16_bf16 v[64:79], v[16:19], v[104:107], v[64:79]
    v_mul_f32 v84, 0xbfb8aa3b, v84
    v_mul_f32 v85, 0xbfb8aa3b, v85
    ds_read_b128 v[104:107], v123 offset:51008
    v_mfma_f32_32x32x16_bf16 v[64:79], v[20:23], v[108:111], v[64:79]
    v_mul_f32 v86, 0xbfb8aa3b, v86
    v_mul_f32 v87, 0xbfb8aa3b, v87
    ds_read_b128 v[108:111], v123 offset:51040
    s_waitcnt lgkmcnt(5)
    v_mfma_f32_32x32x16_bf16 v[64:79], v[24:27], v[112:115], v[64:79]
    v_mul_f32 v88, 0x49800000, v88
    v_mul_f32 v89, 0x49800000, v89
    ds_read_b128 v[112:115], v123 offset:51072
    v_mfma_f32_32x32x16_bf16 v[64:79], v[28:31], v[116:119], v[64:79]
    v_mul_f32 v90, 0x49800000, v90
    v_mul_f32 v91, 0x49800000, v91
    ds_read_b32 v122, v126 offset:96
    ds_read_b128 v[116:119], v123 offset:51104
    s_waitcnt lgkmcnt(5)
    v_mfma_f32_32x32x16_bf16 v[64:79], v[32:35], v[96:99], v[64:79]
    v_mul_f32 v92, 0x49800000, v92
    v_mul_f32 v93, 0x49800000, v93
    ds_read_b128 v[96:99], v123 offset:51136
    v_mfma_f32_32x32x16_bf16 v[64:79], v[36:39], v[100:103], v[64:79]
    v_mul_f32 v94, 0x49800000, v94
    v_mul_f32 v95, 0x49800000, v95
    ds_read_b128 v[100:103], v123 offset:51168
    s_waitcnt lgkmcnt(5)
    v_mfma_f32_32x32x16_bf16 v[64:79], v[40:43], v[104:107], v[64:79]
    v_cvt_pk_bf16_f32 v88, v80, v88
    v_cvt_pk_bf16_f32 v89, v81, v89
    s_waitcnt lgkmcnt(3)
    v_readfirstlane_b32 s56, v122
sp30:
    s_and_b32 s56, s56, 0xfff
    s_cmp_ge_u32 s56, 68
    s_cbranch_scc1 sp30e
    s_sleep 1
sp30r:
    ds_read_b32 v122, v126 offset:96
    s_waitcnt lgkmcnt(0)
    v_readfirstlane_b32 s56, v122
    s_branch sp30
sp30e:
    v_mfma_f32_32x32x16_bf16 v[64:79], v[44:47], v[108:111], v[64:79]
    v_cvt_pk_bf16_f32 v90, v82, v90
    v_cvt_pk_bf16_f32 v91, v83, v91
    s_waitcnt lgkmcnt(2)
    v_mfma_f32_32x32x16_bf16 v[64:79], v[48:51], v[112:115], v[64:79]
    v_cvt_pk_bf16_f32 v92, v84, v92
    v_cvt_pk_bf16_f32 v93, v85, v93
    v_mfma_f32_32x32x16_bf16 v[64:79], v[52:55], v[116:119], v[64:79]
    v_cvt_pk_bf16_f32 v94, v86, v94
    v_cvt_pk_bf16_f32 v95, v87, v95
    s_waitcnt lgkmcnt(0)
    v_mfma_f32_32x32x16_bf16 v[64:79], v[56:59], v[96:99], v[64:79]
    ds_write_b128 v121, v[88:91] offset:0
    ds_write_b128 v121, v[92:95] offset:16
    v_add_u32 v121, 0x2200, v121
    v_mfma_f32_32x32x16_bf16 v[64:79], v[60:63], v[100:103], v[64:79]
    s_nop 11
    v_mul_f32 v64, 0xbfb8aa3b, v64
    v_mul_f32 v65, 0xbfb8aa3b, v65
    v_mul_f32 v66, 0xbfb8aa3b, v66
    v_mul_f32 v67, 0xbfb8aa3b, v67
    v_mul_f32 v68, 0xbfb8aa3b, v68
    v_mul_f32 v69, 0xbfb8aa3b, v69
    v_mul_f32 v70, 0xbfb8aa3b, v70
    v_mul_f32 v71, 0xbfb8aa3b, v71
    v_mul_f32 v72, 0x49800000, v72
    v_mul_f32 v73, 0x49800000, v73
    v_mul_f32 v74, 0x49800000, v74
    v_mul_f32 v75, 0x49800000, v75
    v_mul_f32 v76, 0x49800000, v76
    v_mul_f32 v77, 0x49800000, v77
    v_mul_f32 v78, 0x49800000, v78
    v_mul_f32 v79, 0x49800000, v79
    v_cvt_pk_bf16_f32 v72, v64, v72
    v_cvt_pk_bf16_f32 v73, v65, v73
    v_cvt_pk_bf16_f32 v74, v66, v74
    v_cvt_pk_bf16_f32 v75, v67, v75
    v_cvt_pk_bf16_f32 v76, v68, v76
    v_cvt_pk_bf16_f32 v77, v69, v77
    v_cvt_pk_bf16_f32 v78, v70, v78
    v_cvt_pk_bf16_f32 v79, v71, v79
    ds_write_b128 v121, v[72:75] offset:0
    ds_write_b128 v121, v[76:79] offset:16
    v_mov_b32 v127, 1
    v_mbcnt_lo_u32_b32 v120, -1, 0
    v_mbcnt_hi_u32_b32 v120, -1, v120
    v_lshlrev_b32 v123, 4, v120
    v_add_u32 v123, 100864, v123
    ds_read_b128 v[96:99], v123
    ds_read_b128 v[100:103], v123 offset:1024
    ds_read_b128 v[116:119], v123 offset:2048
    ds_read_b128 v[84:87], v123 offset:3072
    ds_read_b128 v[112:115], v123 offset:4096
    s_mov_b64 exec, 1
    ds_add_u32 v126, v127 offset:56
    s_mov_b64 exec, -1
    s_setprio 0
k_join:
    s_mov_b32 s69, 1
    s_mov_b32 s60, 1
    s_and_b32 s57, s26, 3
    s_lshl_b32 s57, s57, 2
    s_lshr_b32 s58, s26, 2
    s_add_u32 s57, s57, s58
    s_lshl_b32 s57, s57, 3
    v_mov_b32 v123, s57
    v_lshlrev_b32 v124, 4, v120
    s_branch sp31r
sp31:
    s_and_b32 s56, s56, 0xf
    s_cmp_ge_u32 s56, 8
    s_cbranch_scc1 sp31e
    s_sleep 1
sp31r:
    ds_read_b32 v122, v126 offset:68
    s_waitcnt lgkmcnt(0)
    v_readfirstlane_b32 s56, v122
    s_branch sp31
sp31e:
    ds_read_b64 v[0:1], v123 offset:22272
    ds_read_b64 v[2:3], v123 offset:22280
    ds_read_b32 v5, v126 offset:40
    ds_read_b32 v4, v126 offset:108
    ds_read_b128 v[88:91], v124 offset:22528
    ds_read_b128 v[92:95], v124 offset:23552
    s_waitcnt lgkmcnt(2)
    v_readfirstlane_b32 s62, v0
    v_readfirstlane_b32 s64, v1
    v_readfirstlane_b32 s63, v2
    v_readfirstlane_b32 s65, v3
    v_lshlrev_b32 v117, 2, v1
    v_lshl_add_u32 v118, v1, 1, v118
    s_sub_u32 s65, s65, s64
    s_lshr_b32 s65, s65, 2
    s_lshr_b32 s64, s64, 2
    s_mul_i32 s67, s62, 272
    v_readfirstlane_b32 s57, v4
    v_readfirstlane_b32 s56, v5
    s_bfe_u32 s57, s57, 0x1001e
    s_lshl_b32 s57, s57, 21
    s_add_u32 s28, s28, s57
    s_addc_u32 s29, s29, 0
    s_cmp_lg_u32 s56, 0
    s_cbranch_scc1 k_slow
k2_block:
    v_add_u32 v124, s64, v120
    ds_read_b128 v[64:67], v117 offset:0
    ds_read_b128 v[68:71], v117 offset:16
    ds_read_b128 v[72:75], v117 offset:32
    ds_read_b128 v[76:79], v117 offset:48
    s_cmp_eq_u32 s65, 0
    s_cbranch_scc1 k2_epi
    ds_read_u8 v125, v124 offset:21248
    ds_read_u16 v115, v118 offset:12800
    s_min_u32 s57, s65, 64
    s_add_u32 s66, s57, 3
    s_lshr_b32 s66, s66, 2
    s_mov_b32 s68, s67
    v_cmp_gt_u32 vcc, s57, v120
    s_sub_u32 s57, s57, 1
    s_and_b32 s59, s57, 2
    s_waitcnt lgkmcnt(0)
    v_cmp_ne_u32 s[8:9], 0, v125
    s_and_b64 s[8:9], s[8:9], vcc
    s_mov_b64 s[10:11], s[8:9]
    s_bitset0_b64 s[10:11], s57
    s_cmp_eq_u32 s69, 0
    s_cbranch_scc1 k2_g0
    s_branch sp32r
sp32:
    s_cmp_ge_u32 s56, 16648
    s_cbranch_scc1 sp32e
    s_sleep 1
sp32r:
    ds_read_b32 v122, v126 offset:68
    s_waitcnt lgkmcnt(0)
    v_readfirstlane_b32 s56, v122
    s_branch sp32
sp32e:
k2_g0:
    buffer_load_dword v0, v64, s[28:31], 0 offen sc1
    buffer_load_dword v1, v68, s[28:31], 0 offen sc1
    buffer_load_dword v2, v65, s[28:31], 0 offen sc1
    buffer_load_dword v3, v69, s[28:31], 0 offen sc1
    buffer_load_dword v4, v66, s[28:31], 0 offen sc1
    buffer_load_dword v5, v70, s[28:31], 0 offen sc1
    buffer_load_dword v6, v67, s[28:31], 0 offen sc1
    buffer_load_dword v7, v71, s[28:31], 0 offen sc1
    buffer_load_dword v8, v72, s[28:31], 0 offen sc1
    buffer_load_dword v9, v76, s[28:31], 0 offen sc1
    buffer_load_dword v10, v73, s[28:31], 0 offen sc1
    buffer_load_dword v11, v77, s[28:31], 0 offen sc1
    buffer_load_dword v12, v74, s[28:31], 0 offen sc1
    buffer_load_dword v13, v78, s[28:31], 0 offen sc1
    buffer_load_dword v14, v75, s[28:31], 0 offen sc1
    buffer_load_dword v15, v79, s[28:31], 0 offen sc1
    ds_read_b128 v[64:67], v117 offset:64
    ds_read_b128 v[68:71], v117 offset:80
    ds_read_b128 v[72:75], v117 offset:96
    ds_read_b128 v[76:79], v117 offset:112
    s_cmp_eq_u32 s69, 0
    s_cbranch_scc1 k2_nobar
    s_branch sp33r
sp33:
    s_cmp_ge_u32 s56, 4
    s_cbranch_scc1 sp33e
    s_sleep 1
sp33r:
    ds_read_b32 v122, v126 offset:112
    s_waitcnt lgkmcnt(0)
    v_readfirstlane_b32 s56, v122
    s_branch sp33
sp33e:
    s_mov_b32 s69, 0
k2_nobar:
    s_setprio 3
    s_waitcnt lgkmcnt(0)
    v_lshl_add_u32 v116, v115, 5, v119
    ds_read_b128 v[80:83], v116
    ds_read_u16 v115, v118 offset:12832
    s_mov_b32 m0, s68
    s_bitcmp1_b32 s10, 0
    ds_read_addtid_b32 v104 offset:24576
    s_cselect_b32 s56, 272, 0
    s_add_u32 m0, m0, s56
    s_bitcmp1_b32 s10, 1
    ds_read_addtid_b32 v105 offset:24576
    s_cselect_b32 s56, 272, 0
    s_add_u32 m0, m0, s56
    s_bitcmp1_b32 s10, 2
    ds_read_addtid_b32 v106 offset:24576
    s_cselect_b32 s56, 272, 0
    s_add_u32 m0, m0, s56
    s_bitcmp1_b32 s10, 3
    ds_read_addtid_b32 v107 offset:24576
    s_cselect_b32 s56, 272, 0
    s_add_u32 s68, m0, s56
    s_lshr_b64 s[10:11], s[10:11], 4
    buffer_load_dword v16, v64, s[28:31], 0 offen sc1
    buffer_load_dword v17, v68, s[28:31], 0 offen sc1
    buffer_load_dword v18, v65, s[28:31], 0 offen sc1
    buffer_load_dword v19, v69, s[28:31], 0 offen sc1
    buffer_load_dword v20, v66, s[28:31], 0 offen sc1
    buffer_load_dword v21, v70, s[28:31], 0 offen sc1
    buffer_load_dword v22, v67, s[28:31], 0 offen sc1
    buffer_load_dword v23, v71, s[28:31], 0 offen sc1
    buffer_load_dword v24, v72, s[28:31], 0 offen sc1
    buffer_load_dword v25, v76, s[28:31], 0 offen sc1
    buffer_load_dword v26, v73, s[28:31], 0 offen sc1
    buffer_load_dword v27, v77, s[28:31], 0 offen sc1
    buffer_load_dword v28, v74, s[28:31], 0 offen sc1
    buffer_load_dword v29, v78, s[28:31], 0 offen sc1
    buffer_load_dword v30, v75, s[28:31], 0 offen sc1
    buffer_load_dword v31, v79, s[28:31], 0 offen sc1
    ds_read_b128 v[64:67], v117 offset:128
    ds_read_b128 v[68:71], v117 offset:144
    ds_read_b128 v[72:75], v117 offset:160
    ds_read_b128 v[76:79], v117 offset:176
    s_waitcnt lgkmcnt(4)
    v_mfma_f32_32x32x16_bf16 v[32:47], v[100:103], v[104:107], 0
    v_smfmac_f32_32x32x32_bf16 v[32:47], v[80:83], v[88:95], v112
    s_cmp_eq_u32 s60, 0
    s_cbranch_scc1 k2_keep
    v_and_b32 v114, 0xffff0000, v104
k2_keep:
    s_lshr_b32 s60, s9, 31
    v_lshl_add_u32 v116, v115, 5, v119
    ds_read_b128 v[80:83], v116
    ds_read_u16 v115, v118 offset:12864
    s_mov_b32 m0, s68
    s_bitcmp1_b32 s10, 0
    ds_read_addtid_b32 v108 offset:24576
    s_cselect_b32 s56, 272, 0
    s_add_u32 m0, m0, s56
    s_bitcmp1_b32 s10, 1
    ds_read_addtid_b32 v109 offset:24576
    s_cselect_b32 s56, 272, 0
    s_add_u32 m0, m0, s56
    s_bitcmp1_b32 s10, 2
    ds_read_addtid_b32 v110 offset:24576
    s_cselect_b32 s56, 272, 0
    s_add_u32 m0, m0, s56
    s_bitcmp1_b32 s10, 3
    ds_read_addtid_b32 v111 offset:24576
    s_cselect_b32 s56, 272, 0
    s_add_u32 s68, m0, s56
    s_lshr_b64 s[10:11], s[10:11], 4
    s_waitcnt vmcnt(16)
    v_smfmac_f32_32x32x32_bf16 v[32:47], v[96:99], v[0:7], v113
    v_smfmac_f32_32x32x32_bf16 v[32:47], v[84:87], v[8:15], v113
    s_nop 9
    s_cmp_eq_u32 s66, 1
    s_cbranch_scc1 k2_last0
k2_loop:
    v_exp_f32 v32, v32
    v_exp_f32 v33, v33
    v_exp_f32 v34, v34
    v_exp_f32 v35, v35
    s_waitcnt lgkmcnt(0)
    v_mfma_f32_32x32x16_bf16 v[48:63], v[100:103], v[108:111], 0
    v_exp_f32 v36, v36
    v_exp_f32 v37, v37
    v_exp_f32 v38, v38
    v_exp_f32 v39, v39
    v_smfmac_f32_32x32x32_bf16 v[48:63], v[80:83], v[88:95], v112
    v_exp_f32 v40, v40
    v_exp_f32 v41, v41
    v_exp_f32 v42, v42
    v_exp_f32 v43, v43
    v_lshl_add_u32 v116, v115, 5, v119
    ds_read_b128 v[80:83], v116
    ds_read_u16 v115, v118 offset:12896
    v_exp_f32 v44, v44
    v_exp_f32 v45, v45
    v_exp_f32 v46, v46
    v_exp_f32 v47, v47
    v_pk_add_f32 v[122:123], v[32:33], 1.0 op_sel_hi:[1,0]
    v_pk_add_f32 v[126:127], v[40:41], 1.0 op_sel_hi:[1,0]
    v_pk_fma_f32 v[120:121], v[0:1], v[34:35], v[0:1]
    v_pk_fma_f32 v[124:125], v[8:9], v[42:43], v[8:9]
    v_pk_fma_f32 v[120:121], v[2:3], v[122:123], v[120:121]
    v_pk_fma_f32 v[124:125], v[10:11], v[126:127], v[124:125]
    v_pk_fma_f32 v[122:123], v[122:123], v[34:35], v[122:123]
    v_pk_fma_f32 v[126:127], v[126:127], v[42:43], v[126:127]
    v_pk_fma_f32 v[120:121], v[120:121], v[36:37], v[120:121]
    v_pk_fma_f32 v[124:125], v[124:125], v[44:45], v[124:125]
    v_pk_fma_f32 v[120:121], v[4:5], v[122:123], v[120:121]
    v_pk_fma_f32 v[124:125], v[12:13], v[126:127], v[124:125]
    v_pk_fma_f32 v[122:123], v[122:123], v[36:37], v[122:123]
    v_pk_fma_f32 v[126:127], v[126:127], v[44:45], v[126:127]
    v_pk_fma_f32 v[120:121], v[120:121], v[38:39], v[120:121]
    v_pk_fma_f32 v[124:125], v[124:125], v[46:47], v[124:125]
    v_pk_fma_f32 v[120:121], v[6:7], v[122:123], v[120:121]
    v_pk_fma_f32 v[124:125], v[14:15], v[126:127], v[124:125]
    v_pk_fma_f32 v[122:123], v[122:123], v[38:39], v[122:123]
    v_pk_fma_f32 v[126:127], v[126:127], v[46:47], v[126:127]
    v_fma_f32 v116, v122, v123, v126
    v_add_f32 v116, v116, v127
    v_cmp_ngt_f32 vcc, 0x57800000, v116
    s_cbranch_vccnz k2_safe0
k2_ok0:
    s_cmp_le_u32 s66, 2
    s_cbranch_scc1 k2_noload0
    buffer_load_dword v0, v64, s[28:31], 0 offen sc1
    buffer_load_dword v1, v68, s[28:31], 0 offen sc1
    buffer_load_dword v2, v65, s[28:31], 0 offen sc1
    buffer_load_dword v3, v69, s[28:31], 0 offen sc1
    buffer_load_dword v4, v66, s[28:31], 0 offen sc1
    buffer_load_dword v5, v70, s[28:31], 0 offen sc1
    buffer_load_dword v6, v67, s[28:31], 0 offen sc1
    buffer_load_dword v7, v71, s[28:31], 0 offen sc1
    buffer_load_dword v8, v72, s[28:31], 0 offen sc1
    buffer_load_dword v9, v76, s[28:31], 0 offen sc1
    buffer_load_dword v10, v73, s[28:31], 0 offen sc1
    buffer_load_dword v11, v77, s[28:31], 0 offen sc1
    buffer_load_dword v12, v74, s[28:31], 0 offen sc1
    buffer_load_dword v13, v78, s[28:31], 0 offen sc1
    buffer_load_dword v14, v75, s[28:31], 0 offen sc1
    buffer_load_dword v15, v79, s[28:31], 0 offen sc1
    ds_read_b128 v[64:67], v117 offset:192
    ds_read_b128 v[68:71], v117 offset:208
    ds_read_b128 v[72:75], v117 offset:224
    ds_read_b128 v[76:79], v117 offset:240
    s_waitcnt vmcnt(16)
k2_loaded0:
    v_smfmac_f32_32x32x32_bf16 v[48:63], v[96:99], v[16:23], v113
    v_rcp_f32 v122, v122
    v_rcp_f32 v123, v123
    v_rcp_f32 v126, v126
    v_smfmac_f32_32x32x32_bf16 v[48:63], v[84:87], v[24:31], v113
    v_rcp_f32 v127, v127
    s_bitcmp1_b32 s8, 0
    v_fmac_f32 v114, v120, v122
    s_cbranch_scc1 k2_fl0_0
k2_nofl0_0:
    s_bitcmp1_b32 s8, 1
    v_fmac_f32 v114, v121, v123
    s_cbranch_scc1 k2_fl0_1
k2_nofl0_1:
    s_bitcmp1_b32 s8, 2
    v_fmac_f32 v114, v124, v126
    s_cbranch_scc1 k2_fl0_2
k2_nofl0_2:
    s_bitcmp1_b32 s8, 3
    v_fmac_f32 v114, v125, v127
    s_cbranch_scc1 k2_fl0_3
k2_nofl0_3:
    s_mov_b32 m0, s68
    s_bitcmp1_b32 s10, 0
    ds_read_addtid_b32 v104 offset:24576
    s_cselect_b32 s56, 272, 0
    s_add_u32 m0, m0, s56
    s_bitcmp1_b32 s10, 1
    ds_read_addtid_b32 v105 offset:24576
    s_cselect_b32 s56, 272, 0
    s_add_u32 m0, m0, s56
    s_bitcmp1_b32 s10, 2
    ds_read_addtid_b32 v106 offset:24576
    s_cselect_b32 s56, 272, 0
    s_add_u32 m0, m0, s56
    s_bitcmp1_b32 s10, 3
    ds_read_addtid_b32 v107 offset:24576
    s_cselect_b32 s56, 272, 0
    s_add_u32 s68, m0, s56
    s_lshr_b64 s[10:11], s[10:11], 4
    s_lshr_b64 s[8:9], s[8:9], 4
    s_sub_u32 s66, s66, 1
    s_cmp_gt_u32 s66, 4
    s_cbranch_scc0 k2_pr
k2_mid:
    v_exp_f32 v48, v48
    v_exp_f32 v49, v49
    v_exp_f32 v50, v50
    v_exp_f32 v51, v51
    s_waitcnt lgkmcnt(0)
    v_mfma_f32_32x32x16_bf16 v[32:47], v[100:103], v[104:107], 0
    v_exp_f32 v52, v52
    v_exp_f32 v53, v53
    v_exp_f32 v54, v54
    v_exp_f32 v55, v55
    v_smfmac_f32_32x32x32_bf16 v[32:47], v[80:83], v[88:95], v112
    v_exp_f32 v56, v56
    v_exp_f32 v57, v57
    v_exp_f32 v58, v58
    v_exp_f32 v59, v59
    v_lshl_add_u32 v116, v115, 5, v119
    ds_read_b128 v[80:83], v116
    ds_read_u16 v115, v118 offset:12928
    v_exp_f32 v60, v60
    v_exp_f32 v61, v61
    v_exp_f32 v62, v62
    v_exp_f32 v63, v63
    v_pk_add_f32 v[122:123], v[48:49], 1.0 op_sel_hi:[1,0]
    v_pk_add_f32 v[126:127], v[56:57], 1.0 op_sel_hi:[1,0]
    v_pk_fma_f32 v[120:121], v[16:17], v[50:51], v[16:17]
    v_pk_fma_f32 v[124:125], v[24:25], v[58:59], v[24:25]
    v_pk_fma_f32 v[120:121], v[18:19], v[122:123], v[120:121]
    v_pk_fma_f32 v[124:125], v[26:27], v[126:127], v[124:125]
    v_pk_fma_f32 v[122:123], v[122:123], v[50:51], v[122:123]
    v_pk_fma_f32 v[126:127], v[126:127], v[58:59], v[126:127]
    v_pk_fma_f32 v[120:121], v[120:121], v[52:53], v[120:121]
    v_pk_fma_f32 v[124:125], v[124:125], v[60:61], v[124:125]
    v_pk_fma_f32 v[120:121], v[20:21], v[122:123], v[120:121]
    v_pk_fma_f32 v[124:125], v[28:29], v[126:127], v[124:125]
    v_pk_fma_f32 v[122:123], v[122:123], v[52:53], v[122:123]
    v_pk_fma_f32 v[126:127], v[126:127], v[60:61], v[126:127]
    v_pk_fma_f32 v[120:121], v[120:121], v[54:55], v[120:121]
    v_pk_fma_f32 v[124:125], v[124:125], v[62:63], v[124:125]
    v_pk_fma_f32 v[120:121], v[22:23], v[122:123], v[120:121]
    v_pk_fma_f32 v[124:125], v[30:31], v[126:127], v[124:125]
    v_pk_fma_f32 v[122:123], v[122:123], v[54:55], v[122:123]
    v_pk_fma_f32 v[126:127], v[126:127], v[62:63], v[126:127]
    v_fma_f32 v116, v122, v123, v126
    v_add_f32 v116, v116, v127
    v_cmp_ngt_f32 vcc, 0x57800000, v116
    s_cbranch_vccnz k2_safe1
k2_ok1:
    s_cmp_le_u32 s66, 2
    s_cbranch_scc1 k2_noload1
    buffer_load_dword v16, v64, s[28:31], 0 offen sc1
    buffer_load_dword v17, v68, s[28:31], 0 offen sc1
    buffer_load_dword v18, v65, s[28:31], 0 offen sc1
    buffer_load_dword v19, v69, s[28:31], 0 offen sc1
    buffer_load_dword v20, v66, s[28:31], 0 offen sc1
    buffer_load_dword v21, v70, s[28:31], 0 offen sc1
    buffer_load_dword v22, v67, s[28:31], 0 offen sc1
    buffer_load_dword v23, v71, s[28:31], 0 offen sc1
    buffer_load_dword v24, v72, s[28:31], 0 offen sc1
    buffer_load_dword v25, v76, s[28:31], 0 offen sc1
    buffer_load_dword v26, v73, s[28:31], 0 offen sc1
    buffer_load_dword v27, v77, s[28:31], 0 offen sc1
    buffer_load_dword v28, v74, s[28:31], 0 offen sc1
    buffer_load_dword v29, v78, s[28:31], 0 offen sc1
    buffer_load_dword v30, v75, s[28:31], 0 offen sc1
    buffer_load_dword v31, v79, s[28:31], 0 offen sc1
    ds_read_b128 v[64:67], v117 offset:256
    ds_read_b128 v[68:71], v117 offset:272
    ds_read_b128 v[72:75], v117 offset:288
    ds_read_b128 v[76:79], v117 offset:304
    s_waitcnt vmcnt(16)
k2_loaded1:
    v_smfmac_f32_32x32x32_bf16 v[32:47], v[96:99], v[0:7], v113
    v_rcp_f32 v122, v122
    v_rcp_f32 v123, v123
    v_rcp_f32 v126, v126
    v_smfmac_f32_32x32x32_bf16 v[32:47], v[84:87], v[8:15], v113
    v_rcp_f32 v127, v127
    s_bitcmp1_b32 s8, 0
    v_fmac_f32 v114, v120, v122
    s_cbranch_scc1 k2_fl1_0
k2_nofl1_0:
    s_bitcmp1_b32 s8, 1
    v_fmac_f32 v114, v121, v123
    s_cbranch_scc1 k2_fl1_1
k2_nofl1_1:
    s_bitcmp1_b32 s8, 2
    v_fmac_f32 v114, v124, v126
    s_cbranch_scc1 k2_fl1_2
k2_nofl1_2:
    s_bitcmp1_b32 s8, 3
    v_fmac_f32 v114, v125, v127
    s_cbranch_scc1 k2_fl1_3
k2_nofl1_3:
    s_mov_b32 m0, s68
    s_bitcmp1_b32 s10, 0
    ds_read_addtid_b32 v108 offset:24576
    s_cselect_b32 s56, 272, 0
    s_add_u32 m0, m0, s56
    s_bitcmp1_b32 s10, 1
    ds_read_addtid_b32 v109 offset:24576
    s_cselect_b32 s56, 272, 0
    s_add_u32 m0, m0, s56
    s_bitcmp1_b32 s10, 2
    ds_read_addtid_b32 v110 offset:24576
    s_cselect_b32 s56, 272, 0
    s_add_u32 m0, m0, s56
    s_bitcmp1_b32 s10, 3
    ds_read_addtid_b32 v111 offset:24576
    s_cselect_b32 s56, 272, 0
    s_add_u32 s68, m0, s56
    s_lshr_b64 s[10:11], s[10:11], 4
    s_lshr_b64 s[8:9], s[8:9], 4
    v_add_u32 v117, 128, v117
    v_add_u32 v118, 64, v118
    s_sub_u32 s66, s66, 1
    s_cmp_gt_u32 s66, 4
    s_cbranch_scc1 k2_loop
    s_setprio 2
    s_cmp_gt_u32 s66, 2
    s_cbranch_scc1 k2_loop
    s_setprio 1
    s_cmp_gt_u32 s66, 1
    s_cbranch_scc1 k2_loop
k2_last0:
    s_setprio 0
    s_cmp_eq_u32 s59, 0
    s_cbranch_scc1 k2_half0
    v_exp_f32 v32, v32
    v_exp_f32 v33, v33
    v_exp_f32 v34, v34
    v_exp_f32 v35, v35
    v_exp_f32 v36, v36
    v_exp_f32 v37, v37
    v_exp_f32 v38, v38
    v_exp_f32 v39, v39
    v_exp_f32 v40, v40
    v_exp_f32 v41, v41
    v_exp_f32 v42, v42
    v_exp_f32 v43, v43
    v_exp_f32 v44, v44
    v_exp_f32 v45, v45
    v_exp_f32 v46, v46
    v_exp_f32 v47, v47
    v_pk_add_f32 v[122:123], v[32:33], 1.0 op_sel_hi:[1,0]
    v_pk_add_f32 v[126:127], v[40:41], 1.0 op_sel_hi:[1,0]
    v_pk_fma_f32 v[120:121], v[0:1], v[34:35], v[0:1]
    v_pk_fma_f32 v[124:125], v[8:9], v[42:43], v[8:9]
    v_pk_fma_f32 v[120:121], v[2:3], v[122:123], v[120:121]
    v_pk_fma_f32 v[124:125], v[10:11], v[126:127], v[124:125]
    v_pk_fma_f32 v[122:123], v[122:123], v[34:35], v[122:123]
    v_pk_fma_f32 v[126:127], v[126:127], v[42:43], v[126:127]
    v_pk_fma_f32 v[120:121], v[120:121], v[36:37], v[120:121]
    v_pk_fma_f32 v[124:125], v[124:125], v[44:45], v[124:125]
    v_pk_fma_f32 v[120:121], v[4:5], v[122:123], v[120:121]
    v_pk_fma_f32 v[124:125], v[12:13], v[126:127], v[124:125]
    v_pk_fma_f32 v[122:123], v[122:123], v[36:37], v[122:123]
    v_pk_fma_f32 v[126:127], v[126:127], v[44:45], v[126:127]
    v_pk_fma_f32 v[120:121], v[120:121], v[38:39], v[120:121]
    v_pk_fma_f32 v[124:125], v[124:125], v[46:47], v[124:125]
    v_pk_fma_f32 v[120:121], v[6:7], v[122:123], v[120:121]
    v_pk_fma_f32 v[124:125], v[14:15], v[126:127], v[124:125]
    v_pk_fma_f32 v[122:123], v[122:123], v[38:39], v[122:123]
    v_pk_fma_f32 v[126:127], v[126:127], v[46:47], v[126:127]
    v_fma_f32 v116, v122, v123, v126
    v_add_f32 v116, v116, v127
    v_cmp_ngt_f32 vcc, 0x57800000, v116
    s_cbranch_vccnz k2_safe2
k2_ok2:
    v_rcp_f32 v122, v122
    v_rcp_f32 v123, v123
    v_rcp_f32 v126, v126
    v_rcp_f32 v127, v127
    s_bitcmp1_b32 s8, 0
    v_fmac_f32 v114, v120, v122
    s_cbranch_scc1 k2_fll0_0
k2_nofll0_0:
    s_bitcmp1_b32 s8, 1
    v_fmac_f32 v114, v121, v123
    s_cbranch_scc1 k2_fll0_1
k2_nofll0_1:
    s_bitcmp1_b32 s8, 2
    v_fmac_f32 v114, v124, v126
    s_cbranch_scc1 k2_fll0_2
k2_nofll0_2:
    s_bitcmp1_b32 s8, 3
    v_fmac_f32 v114, v125, v127
    s_cbranch_scc1 k2_fll0_3
k2_nofll0_3:
    s_branch k2_loopend
k2_half0:
    v_exp_f32 v32, v32
    v_exp_f32 v33, v33
    v_exp_f32 v34, v34
    v_exp_f32 v35, v35
    v_exp_f32 v36, v36
    v_exp_f32 v37, v37
    v_exp_f32 v38, v38
    v_exp_f32 v39, v39
    v_pk_add_f32 v[122:123], v[32:33], 1.0 op_sel_hi:[1,0]
    v_pk_fma_f32 v[120:121], v[0:1], v[34:35], v[0:1]
    v_pk_fma_f32 v[120:121], v[2:3], v[122:123], v[120:121]
    v_pk_fma_f32 v[122:123], v[122:123], v[34:35], v[122:123]
    v_pk_fma_f32 v[120:121], v[120:121], v[36:37], v[120:121]
    v_pk_fma_f32 v[120:121], v[4:5], v[122:123], v[120:121]
    v_pk_fma_f32 v[122:123], v[122:123], v[36:37], v[122:123]
    v_pk_fma_f32 v[120:121], v[120:121], v[38:39], v[120:121]
    v_pk_fma_f32 v[120:121], v[6:7], v[122:123], v[120:121]
    v_pk_fma_f32 v[122:123], v[122:123], v[38:39], v[122:123]
    v_add_f32 v116, v122, v123
    v_cmp_ngt_f32 vcc, 0x57800000, v116
    s_cbranch_vccnz k2_safe4
k2_ok4:
    v_rcp_f32 v122, v122
    v_rcp_f32 v123, v123
    s_nop 0
    s_bitcmp1_b32 s8, 0
    v_fmac_f32 v114, v120, v122
    s_cbranch_scc1 k2_flh0_0
k2_noflh0_0:
    s_bitcmp1_b32 s8, 1
    v_fmac_f32 v114, v121, v123
    s_cbranch_scc1 k2_flh0_1
k2_noflh0_1:
    s_branch k2_loopend
k2_last1:
    s_setprio 0
    s_cmp_eq_u32 s59, 0
    s_cbranch_scc1 k2_half1
    v_exp_f32 v48, v48
    v_exp_f32 v49, v49
    v_exp_f32 v50, v50
    v_exp_f32 v51, v51
    v_exp_f32 v52, v52
    v_exp_f32 v53, v53
    v_exp_f32 v54, v54
    v_exp_f32 v55, v55
    v_exp_f32 v56, v56
    v_exp_f32 v57, v57
    v_exp_f32 v58, v58
    v_exp_f32 v59, v59
    v_exp_f32 v60, v60
    v_exp_f32 v61, v61
    v_exp_f32 v62, v62
    v_exp_f32 v63, v63
    v_pk_add_f32 v[122:123], v[48:49], 1.0 op_sel_hi:[1,0]
    v_pk_add_f32 v[126:127], v[56:57], 1.0 op_sel_hi:[1,0]
    v_pk_fma_f32 v[120:121], v[16:17], v[50:51], v[16:17]
    v_pk_fma_f32 v[124:125], v[24:25], v[58:59], v[24:25]
    v_pk_fma_f32 v[120:121], v[18:19], v[122:123], v[120:121]
    v_pk_fma_f32 v[124:125], v[26:27], v[126:127], v[124:125]
    v_pk_fma_f32 v[122:123], v[122:123], v[50:51], v[122:123]
    v_pk_fma_f32 v[126:127], v[126:127], v[58:59], v[126:127]
    v_pk_fma_f32 v[120:121], v[120:121], v[52:53], v[120:121]
    v_pk_fma_f32 v[124:125], v[124:125], v[60:61], v[124:125]
    v_pk_fma_f32 v[120:121], v[20:21], v[122:123], v[120:121]
    v_pk_fma_f32 v[124:125], v[28:29], v[126:127], v[124:125]
    v_pk_fma_f32 v[122:123], v[122:123], v[52:53], v[122:123]
    v_pk_fma_f32 v[126:127], v[126:127], v[60:61], v[126:127]
    v_pk_fma_f32 v[120:121], v[120:121], v[54:55], v[120:121]
    v_pk_fma_f32 v[124:125], v[124:125], v[62:63], v[124:125]
    v_pk_fma_f32 v[120:121], v[22:23], v[122:123], v[120:121]
    v_pk_fma_f32 v[124:125], v[30:31], v[126:127], v[124:125]
    v_pk_fma_f32 v[122:123], v[122:123], v[54:55], v[122:123]
    v_pk_fma_f32 v[126:127], v[126:127], v[62:63], v[126:127]
    v_fma_f32 v116, v122, v123, v126
    v_add_f32 v116, v116, v127
    v_cmp_ngt_f32 vcc, 0x57800000, v116
    s_cbranch_vccnz k2_safe3
k2_ok3:
    v_rcp_f32 v122, v122
    v_rcp_f32 v123, v123
    v_rcp_f32 v126, v126
    v_rcp_f32 v127, v127
    s_bitcmp1_b32 s8, 0
    v_fmac_f32 v114, v120, v122
    s_cbranch_scc1 k2_fll1_0
k2_nofll1_0:
    s_bitcmp1_b32 s8, 1
    v_fmac_f32 v114, v121, v123
    s_cbranch_scc1 k2_fll1_1
k2_nofll1_1:
    s_bitcmp1_b32 s8, 2
    v_fmac_f32 v114, v124, v126
    s_cbranch_scc1 k2_fll1_2
k2_nofll1_2:
    s_bitcmp1_b32 s8, 3
    v_fmac_f32 v114, v125, v127
    s_cbranch_scc1 k2_fll1_3
k2_nofll1_3:
    s_branch k2_loopend
k2_half1:
    v_exp_f32 v48, v48
    v_exp_f32 v49, v49
    v_exp_f32 v50, v50
    v_exp_f32 v51, v51
    v_exp_f32 v52, v52
    v_exp_f32 v53, v53
    v_exp_f32 v54, v54
    v_exp_f32 v55, v55
    v_pk_add_f32 v[122:123], v[48:49], 1.0 op_sel_hi:[1,0]
    v_pk_fma_f32 v[120:121], v[16:17], v[50:51], v[16:17]
    v_pk_fma_f32 v[120:121], v[18:19], v[122:123], v[120:121]
    v_pk_fma_f32 v[122:123], v[122:123], v[50:51], v[122:123]
    v_pk_fma_f32 v[120:121], v[120:121], v[52:53], v[120:121]
    v_pk_fma_f32 v[120:121], v[20:21], v[122:123], v[120:121]
    v_pk_fma_f32 v[122:123], v[122:123], v[52:53], v[122:123]
    v_pk_fma_f32 v[120:121], v[120:121], v[54:55], v[120:121]
    v_pk_fma_f32 v[120:121], v[22:23], v[122:123], v[120:121]
    v_pk_fma_f32 v[122:123], v[122:123], v[54:55], v[122:123]
    v_add_f32 v116, v122, v123
    v_cmp_ngt_f32 vcc, 0x57800000, v116
    s_cbranch_vccnz k2_safe5
k2_ok5:
    v_rcp_f32 v122, v122
    v_rcp_f32 v123, v123
    s_nop 0
    s_bitcmp1_b32 s8, 0
    v_fmac_f32 v114, v120, v122
    s_cbranch_scc1 k2_flh1_0
k2_noflh1_0:
    s_bitcmp1_b32 s8, 1
    v_fmac_f32 v114, v121, v123
    s_cbranch_scc1 k2_flh1_1
k2_noflh1_1:
k2_loopend:
    v_mbcnt_lo_u32_b32 v120, -1, 0
    v_mbcnt_hi_u32_b32 v120, -1, v120
    s_cmp_le_u32 s65, 64
    s_cbranch_scc1 k2_epi
    s_sub_u32 s65, s65, 64
    s_add_u32 s64, s64, 64
    v_add_u32 v117, 128, v117
    v_add_u32 v118, 64, v118
    s_waitcnt lgkmcnt(0)
    s_branch k2_block
k2_noload0:
    s_waitcnt vmcnt(0)
    s_branch k2_loaded0
k2_noload1:
    s_waitcnt vmcnt(0)
    s_branch k2_loaded1
k2_fl0_0:
    s_mov_b32 m0, s67
    s_add_u32 s67, s67, 272
    ds_write_addtid_b32 v114 offset:24576
    v_and_b32 v114, 0xffff0000, v105
    s_branch k2_nofl0_0
k2_fl0_1:
    s_mov_b32 m0, s67
    s_add_u32 s67, s67, 272
    ds_write_addtid_b32 v114 offset:24576
    v_and_b32 v114, 0xffff0000, v106
    s_branch k2_nofl0_1
k2_fl0_2:
    s_mov_b32 m0, s67
    s_add_u32 s67, s67, 272
    ds_write_addtid_b32 v114 offset:24576
    v_and_b32 v114, 0xffff0000, v107
    s_branch k2_nofl0_2
k2_fl0_3:
    s_mov_b32 m0, s67
    s_add_u32 s67, s67, 272
    ds_write_addtid_b32 v114 offset:24576
    v_and_b32 v114, 0xffff0000, v108
    s_branch k2_nofl0_3
k2_pr:
    s_setprio 2
    s_cmp_gt_u32 s66, 2
    s_cbranch_scc1 k2_mid
    s_setprio 1
    s_cmp_gt_u32 s66, 1
    s_cbranch_scc1 k2_mid
    s_branch k2_last1
k2_fl1_0:
    s_mov_b32 m0, s67
    s_add_u32 s67, s67, 272
    ds_write_addtid_b32 v114 offset:24576
    v_and_b32 v114, 0xffff0000, v109
    s_branch k2_nofl1_0
k2_fl1_1:
    s_mov_b32 m0, s67
    s_add_u32 s67, s67, 272
    ds_write_addtid_b32 v114 offset:24576
    v_and_b32 v114, 0xffff0000, v110
    s_branch k2_nofl1_1
k2_fl1_2:
    s_mov_b32 m0, s67
    s_add_u32 s67, s67, 272
    ds_write_addtid_b32 v114 offset:24576
    v_and_b32 v114, 0xffff0000, v111
    s_branch k2_nofl1_2
k2_fl1_3:
    s_mov_b32 m0, s67
    s_add_u32 s67, s67, 272
    ds_write_addtid_b32 v114 offset:24576
    v_and_b32 v114, 0xffff0000, v104
    s_branch k2_nofl1_3
k2_fll0_0:
    s_mov_b32 m0, s67
    s_add_u32 s67, s67, 272
    ds_write_addtid_b32 v114 offset:24576
    v_and_b32 v114, 0xffff0000, v105
    s_branch k2_nofll0_0
k2_fll0_1:
    s_mov_b32 m0, s67
    s_add_u32 s67, s67, 272
    ds_write_addtid_b32 v114 offset:24576
    v_and_b32 v114, 0xffff0000, v106
    s_branch k2_nofll0_1
k2_fll0_2:
    s_mov_b32 m0, s67
    s_add_u32 s67, s67, 272
    ds_write_addtid_b32 v114 offset:24576
    v_and_b32 v114, 0xffff0000, v107
    s_branch k2_nofll0_2
k2_fll0_3:
    s_mov_b32 m0, s67
    s_add_u32 s67, s67, 272
    ds_write_addtid_b32 v114 offset:24576
    v_and_b32 v114, 0xffff0000, v108
    s_branch k2_nofll0_3
k2_flh0_0:
    s_mov_b32 m0, s67
    s_add_u32 s67, s67, 272
    ds_write_addtid_b32 v114 offset:24576
    v_and_b32 v114, 0xffff0000, v105
    s_branch k2_noflh0_0
k2_flh0_1:
    s_mov_b32 m0, s67
    s_add_u32 s67, s67, 272
    ds_write_addtid_b32 v114 offset:24576
    v_and_b32 v114, 0xffff0000, v106
    s_branch k2_noflh0_1
k2_fll1_0:
    s_mov_b32 m0, s67
    s_add_u32 s67, s67, 272
    ds_write_addtid_b32 v114 offset:24576
    v_and_b32 v114, 0xffff0000, v109
    s_branch k2_nofll1_0
k2_fll1_1:
    s_mov_b32 m0, s67
    s_add_u32 s67, s67, 272
    ds_write_addtid_b32 v114 offset:24576
    v_and_b32 v114, 0xffff0000, v110
    s_branch k2_nofll1_1
k2_fll1_2:
    s_mov_b32 m0, s67
    s_add_u32 s67, s67, 272
    ds_write_addtid_b32 v114 offset:24576
    v_and_b32 v114, 0xffff0000, v111
    s_branch k2_nofll1_2
k2_fll1_3:
    s_mov_b32 m0, s67
    s_add_u32 s67, s67, 272
    ds_write_addtid_b32 v114 offset:24576
    v_and_b32 v114, 0xffff0000, v104
    s_branch k2_nofll1_3
k2_flh1_0:
    s_mov_b32 m0, s67
    s_add_u32 s67, s67, 272
    ds_write_addtid_b32 v114 offset:24576
    v_and_b32 v114, 0xffff0000, v109
    s_branch k2_noflh1_0
k2_flh1_1:
    s_mov_b32 m0, s67
    s_add_u32 s67, s67, 272
    ds_write_addtid_b32 v114 offset:24576
    v_and_b32 v114, 0xffff0000, v110
    s_branch k2_noflh1_1
k2_safe0:
    v_mov_b32 v120, 0x30800000
    v_mov_b32 v121, 0x30800000
    v_pk_fma_f32 v[32:33], v[32:33], v[120:121], v[120:121] clamp
    v_pk_fma_f32 v[34:35], v[34:35], v[120:121], v[120:121] clamp
    v_pk_fma_f32 v[36:37], v[36:37], v[120:121], v[120:121] clamp
    v_pk_fma_f32 v[38:39], v[38:39], v[120:121], v[120:121] clamp
    v_pk_mul_f32 v[0:1], v[0:1], v[34:35]
    v_pk_mul_f32 v[4:5], v[4:5], v[38:39]
    v_pk_fma_f32 v[0:1], v[2:3], v[32:33], v[0:1]
    v_pk_fma_f32 v[4:5], v[6:7], v[36:37], v[4:5]
    v_pk_mul_f32 v[32:33], v[32:33], v[34:35]
    v_pk_mul_f32 v[36:37], v[36:37], v[38:39]
    v_pk_mul_f32 v[34:35], v[32:33], v[36:37]
    v_pk_mul_f32 v[38:39], v[0:1], v[36:37]
    v_pk_fma_f32 v[38:39], v[4:5], v[32:33], v[38:39]
    v_mov_b32 v32, 0x4e800000
    v_mov_b32 v120, v38
    v_mov_b32 v121, v39
    v_mul_f32 v122, v32, v34
    v_mul_f32 v123, v32, v35
    v_mov_b32 v124, 0x30800000
    v_mov_b32 v125, 0x30800000
    v_pk_fma_f32 v[40:41], v[40:41], v[124:125], v[124:125] clamp
    v_pk_fma_f32 v[42:43], v[42:43], v[124:125], v[124:125] clamp
    v_pk_fma_f32 v[44:45], v[44:45], v[124:125], v[124:125] clamp
    v_pk_fma_f32 v[46:47], v[46:47], v[124:125], v[124:125] clamp
    v_pk_mul_f32 v[8:9], v[8:9], v[42:43]
    v_pk_mul_f32 v[12:13], v[12:13], v[46:47]
    v_pk_fma_f32 v[8:9], v[10:11], v[40:41], v[8:9]
    v_pk_fma_f32 v[12:13], v[14:15], v[44:45], v[12:13]
    v_pk_mul_f32 v[40:41], v[40:41], v[42:43]
    v_pk_mul_f32 v[44:45], v[44:45], v[46:47]
    v_pk_mul_f32 v[42:43], v[40:41], v[44:45]
    v_pk_mul_f32 v[46:47], v[8:9], v[44:45]
    v_pk_fma_f32 v[46:47], v[12:13], v[40:41], v[46:47]
    v_mov_b32 v40, 0x4e800000
    v_mov_b32 v124, v46
    v_mov_b32 v125, v47
    v_mul_f32 v126, v40, v42
    v_mul_f32 v127, v40, v43
    s_branch k2_ok0
k2_safe1:
    v_mov_b32 v120, 0x30800000
    v_mov_b32 v121, 0x30800000
    v_pk_fma_f32 v[48:49], v[48:49], v[120:121], v[120:121] clamp
    v_pk_fma_f32 v[50:51], v[50:51], v[120:121], v[120:121] clamp
    v_pk_fma_f32 v[52:53], v[52:53], v[120:121], v[120:121] clamp
    v_pk_fma_f32 v[54:55], v[54:55], v[120:121], v[120:121] clamp
    v_pk_mul_f32 v[16:17], v[16:17], v[50:51]
    v_pk_mul_f32 v[20:21], v[20:21], v[54:55]
    v_pk_fma_f32 v[16:17], v[18:19], v[48:49], v[16:17]
    v_pk_fma_f32 v[20:21], v[22:23], v[52:53], v[20:21]
    v_pk_mul_f32 v[48:49], v[48:49], v[50:51]
    v_pk_mul_f32 v[52:53], v[52:53], v[54:55]
    v_pk_mul_f32 v[50:51], v[48:49], v[52:53]
    v_pk_mul_f32 v[54:55], v[16:17], v[52:53]
    v_pk_fma_f32 v[54:55], v[20:21], v[48:49], v[54:55]
    v_mov_b32 v48, 0x4e800000
    v_mov_b32 v120, v54
    v_mov_b32 v121, v55
    v_mul_f32 v122, v48, v50
    v_mul_f32 v123, v48, v51
    v_mov_b32 v124, 0x30800000
    v_mov_b32 v125, 0x30800000
    v_pk_fma_f32 v[56:57], v[56:57], v[124:125], v[124:125] clamp
    v_pk_fma_f32 v[58:59], v[58:59], v[124:125], v[124:125] clamp
    v_pk_fma_f32 v[60:61], v[60:61], v[124:125], v[124:125] clamp
    v_pk_fma_f32 v[62:63], v[62:63], v[124:125], v[124:125] clamp
    v_pk_mul_f32 v[24:25], v[24:25], v[58:59]
    v_pk_mul_f32 v[28:29], v[28:29], v[62:63]
    v_pk_fma_f32 v[24:25], v[26:27], v[56:57], v[24:25]
    v_pk_fma_f32 v[28:29], v[30:31], v[60:61], v[28:29]
    v_pk_mul_f32 v[56:57], v[56:57], v[58:59]
    v_pk_mul_f32 v[60:61], v[60:61], v[62:63]
    v_pk_mul_f32 v[58:59], v[56:57], v[60:61]
    v_pk_mul_f32 v[62:63], v[24:25], v[60:61]
    v_pk_fma_f32 v[62:63], v[28:29], v[56:57], v[62:63]
    v_mov_b32 v56, 0x4e800000
    v_mov_b32 v124, v62
    v_mov_b32 v125, v63
    v_mul_f32 v126, v56, v58
    v_mul_f32 v127, v56, v59
    s_branch k2_ok1
k2_safe2:
    v_mov_b32 v120, 0x30800000
    v_mov_b32 v121, 0x30800000
    v_pk_fma_f32 v[32:33], v[32:33], v[120:121], v[120:121] clamp
    v_pk_fma_f32 v[34:35], v[34:35], v[120:121], v[120:121] clamp
    v_pk_fma_f32 v[36:37], v[36:37], v[120:121], v[120:121] clamp
    v_pk_fma_f32 v[38:39], v[38:39], v[120:121], v[120:121] clamp
    v_pk_mul_f32 v[0:1], v[0:1], v[34:35]
    v_pk_mul_f32 v[4:5], v[4:5], v[38:39]
    v_pk_fma_f32 v[0:1], v[2:3], v[32:33], v[0:1]
    v_pk_fma_f32 v[4:5], v[6:7], v[36:37], v[4:5]
    v_pk_mul_f32 v[32:33], v[32:33], v[34:35]
    v_pk_mul_f32 v[36:37], v[36:37], v[38:39]
    v_pk_mul_f32 v[34:35], v[32:33], v[36:37]
    v_pk_mul_f32 v[38:39], v[0:1], v[36:37]
    v_pk_fma_f32 v[38:39], v[4:5], v[32:33], v[38:39]
    v_mov_b32 v32, 0x4e800000
    v_mov_b32 v120, v38
    v_mov_b32 v121, v39
    v_mul_f32 v122, v32, v34
    v_mul_f32 v123, v32, v35
    v_mov_b32 v124, 0x30800000
    v_mov_b32 v125, 0x30800000
    v_pk_fma_f32 v[40:41], v[40:41], v[124:125], v[124:125] clamp
    v_pk_fma_f32 v[42:43], v[42:43], v[124:125], v[124:125] clamp
    v_pk_fma_f32 v[44:45], v[44:45], v[124:125], v[124:125] clamp
    v_pk_fma_f32 v[46:47], v[46:47], v[124:125], v[124:125] clamp
    v_pk_mul_f32 v[8:9], v[8:9], v[42:43]
    v_pk_mul_f32 v[12:13], v[12:13], v[46:47]
    v_pk_fma_f32 v[8:9], v[10:11], v[40:41], v[8:9]
    v_pk_fma_f32 v[12:13], v[14:15], v[44:45], v[12:13]
    v_pk_mul_f32 v[40:41], v[40:41], v[42:43]
    v_pk_mul_f32 v[44:45], v[44:45], v[46:47]
    v_pk_mul_f32 v[42:43], v[40:41], v[44:45]
    v_pk_mul_f32 v[46:47], v[8:9], v[44:45]
    v_pk_fma_f32 v[46:47], v[12:13], v[40:41], v[46:47]
    v_mov_b32 v40, 0x4e800000
    v_mov_b32 v124, v46
    v_mov_b32 v125, v47
    v_mul_f32 v126, v40, v42
    v_mul_f32 v127, v40, v43
    s_branch k2_ok2
k2_safe3:
    v_mov_b32 v120, 0x30800000
    v_mov_b32 v121, 0x30800000
    v_pk_fma_f32 v[48:49], v[48:49], v[120:121], v[120:121] clamp
    v_pk_fma_f32 v[50:51], v[50:51], v[120:121], v[120:121] clamp
    v_pk_fma_f32 v[52:53], v[52:53], v[120:121], v[120:121] clamp
    v_pk_fma_f32 v[54:55], v[54:55], v[120:121], v[120:121] clamp
    v_pk_mul_f32 v[16:17], v[16:17], v[50:51]
    v_pk_mul_f32 v[20:21], v[20:21], v[54:55]
    v_pk_fma_f32 v[16:17], v[18:19], v[48:49], v[16:17]
    v_pk_fma_f32 v[20:21], v[22:23], v[52:53], v[20:21]
    v_pk_mul_f32 v[48:49], v[48:49], v[50:51]
    v_pk_mul_f32 v[52:53], v[52:53], v[54:55]
    v_pk_mul_f32 v[50:51], v[48:49], v[52:53]
    v_pk_mul_f32 v[54:55], v[16:17], v[52:53]
    v_pk_fma_f32 v[54:55], v[20:21], v[48:49], v[54:55]
    v_mov_b32 v48, 0x4e800000
    v_mov_b32 v120, v54
    v_mov_b32 v121, v55
    v_mul_f32 v122, v48, v50
    v_mul_f32 v123, v48, v51
    v_mov_b32 v124, 0x30800000
    v_mov_b32 v125, 0x30800000
    v_pk_fma_f32 v[56:57], v[56:57], v[124:125], v[124:125] clamp
    v_pk_fma_f32 v[58:59], v[58:59], v[124:125], v[124:125] clamp
    v_pk_fma_f32 v[60:61], v[60:61], v[124:125], v[124:125] clamp
    v_pk_fma_f32 v[62:63], v[62:63], v[124:125], v[124:125] clamp
    v_pk_mul_f32 v[24:25], v[24:25], v[58:59]
    v_pk_mul_f32 v[28:29], v[28:29], v[62:63]
    v_pk_fma_f32 v[24:25], v[26:27], v[56:57], v[24:25]
    v_pk_fma_f32 v[28:29], v[30:31], v[60:61], v[28:29]
    v_pk_mul_f32 v[56:57], v[56:57], v[58:59]
    v_pk_mul_f32 v[60:61], v[60:61], v[62:63]
    v_pk_mul_f32 v[58:59], v[56:57], v[60:61]
    v_pk_mul_f32 v[62:63], v[24:25], v[60:61]
    v_pk_fma_f32 v[62:63], v[28:29], v[56:57], v[62:63]
    v_mov_b32 v56, 0x4e800000
    v_mov_b32 v124, v62
    v_mov_b32 v125, v63
    v_mul_f32 v126, v56, v58
    v_mul_f32 v127, v56, v59
    s_branch k2_ok3
k2_safe4:
    v_mov_b32 v120, 0x30800000
    v_mov_b32 v121, 0x30800000
    v_pk_fma_f32 v[32:33], v[32:33], v[120:121], v[120:121] clamp
    v_pk_fma_f32 v[34:35], v[34:35], v[120:121], v[120:121] clamp
    v_pk_fma_f32 v[36:37], v[36:37], v[120:121], v[120:121] clamp
    v_pk_fma_f32 v[38:39], v[38:39], v[120:121], v[120:121] clamp
    v_pk_mul_f32 v[0:1], v[0:1], v[34:35]
    v_pk_mul_f32 v[4:5], v[4:5], v[38:39]
    v_pk_fma_f32 v[0:1], v[2:3], v[32:33], v[0:1]
    v_pk_fma_f32 v[4:5], v[6:7], v[36:37], v[4:5]
    v_pk_mul_f32 v[32:33], v[32:33], v[34:35]
    v_pk_mul_f32 v[36:37], v[36:37], v[38:39]
    v_pk_mul_f32 v[34:35], v[32:33], v[36:37]
    v_pk_mul_f32 v[38:39], v[0:1], v[36:37]
    v_pk_fma_f32 v[38:39], v[4:5], v[32:33], v[38:39]
    v_mov_b32 v32, 0x4e800000
    v_mov_b32 v120, v38
    v_mov_b32 v121, v39
    v_mul_f32 v122, v32, v34
    v_mul_f32 v123, v32, v35
    s_branch k2_ok4
k2_safe5:
    v_mov_b32 v120, 0x30800000
    v_mov_b32 v121, 0x30800000
    v_pk_fma_f32 v[48:49], v[48:49], v[120:121], v[120:121] clamp
    v_pk_fma_f32 v[50:51], v[50:51], v[120:121], v[120:121] clamp
    v_pk_fma_f32 v[52:53], v[52:53], v[120:121], v[120:121] clamp
    v_pk_fma_f32 v[54:55], v[54:55], v[120:121], v[120:121] clamp
    v_pk_mul_f32 v[16:17], v[16:17], v[50:51]
    v_pk_mul_f32 v[20:21], v[20:21], v[54:55]
    v_pk_fma_f32 v[16:17], v[18:19], v[48:49], v[16:17]
    v_pk_fma_f32 v[20:21], v[22:23], v[52:53], v[20:21]
    v_pk_mul_f32 v[48:49], v[48:49], v[50:51]
    v_pk_mul_f32 v[52:53], v[52:53], v[54:55]
    v_pk_mul_f32 v[50:51], v[48:49], v[52:53]
    v_pk_mul_f32 v[54:55], v[16:17], v[52:53]
    v_pk_fma_f32 v[54:55], v[20:21], v[48:49], v[54:55]
    v_mov_b32 v48, 0x4e800000
    v_mov_b32 v120, v54
    v_mov_b32 v121, v55
    v_mul_f32 v122, v48, v50
    v_mul_f32 v123, v48, v51
    s_branch k2_ok5
k_slow:
    s_setprio 0
    s_branch sp34r
sp34:
    s_cmp_ge_u32 s56, 16648
    s_cbranch_scc1 sp34e
    s_sleep 1
sp34r:
    ds_read_b32 v122, v126 offset:68
    s_waitcnt lgkmcnt(0)
    v_readfirstlane_b32 s56, v122
    s_branch sp34
sp34e:
    s_branch sp35r
sp35:
    s_cmp_ge_u32 s56, 4
    s_cbranch_scc1 sp35e
    s_sleep 1
sp35r:
    ds_read_b32 v122, v126 offset:112
    s_waitcnt lgkmcnt(0)
    v_readfirstlane_b32 s56, v122
    s_branch sp35
sp35e:
    s_load_dwordx2 s[36:37], s[0:1], 24
    s_load_dwordx2 s[40:41], s[0:1], 16
    s_load_dwordx2 s[44:45], s[0:1], 8
    s_load_dwordx2 s[48:49], s[0:1], 48
    v_lshlrev_b32 v18, 2, v120
    v_lshlrev_b32 v19, 1, v120
    s_lshl_b32 s56, s26, 10
    s_add_u32 s56, s56, 68096
    v_lshl_add_u32 v22, v120, 4, s56
    v_mov_b32 v24, 0
    v_mov_b32 v25, 0
    v_mov_b32 v26, 0
    v_mov_b32 v27, 0
    ds_write_b128 v22, v[24:27] offset:0
    ds_write_b128 v22, v[24:27] offset:16384
    ds_write_b128 v22, v[24:27] offset:32768
    s_waitcnt lgkmcnt(0)
    s_mov_b32 s38, 640000
    s_mov_b32 s39, 0x20000
    s_mov_b32 s42, 640000
    s_mov_b32 s43, 0x20000
    s_mov_b32 s46, 5120000
    s_mov_b32 s47, 0x20000
    s_mov_b32 s50, 270336
    s_mov_b32 s51, 0x20000
    s_lshl_b32 s56, s25, 7
    s_add_u32 s56, s56, 262144
    s_add_u32 s57, s56, 4096
    buffer_load_ushort v0, v19, s[48:51], s56 offen offset:0
    buffer_load_ushort v1, v19, s[48:51], s56 offen offset:512
    buffer_load_ushort v2, v19, s[48:51], s56 offen offset:1024
    buffer_load_ushort v3, v19, s[48:51], s56 offen offset:1536
    buffer_load_ushort v4, v19, s[48:51], s56 offen offset:2048
    buffer_load_ushort v5, v19, s[48:51], s56 offen offset:2560
    buffer_load_ushort v6, v19, s[48:51], s56 offen offset:3072
    buffer_load_ushort v7, v19, s[48:51], s56 offen offset:3584
    buffer_load_ushort v8, v19, s[48:51], s57 offen offset:0
    buffer_load_ushort v9, v19, s[48:51], s57 offen offset:512
    buffer_load_ushort v10, v19, s[48:51], s57 offen offset:1024
    buffer_load_ushort v11, v19, s[48:51], s57 offen offset:1536
    buffer_load_ushort v12, v19, s[48:51], s57 offen offset:2048
    buffer_load_ushort v13, v19, s[48:51], s57 offen offset:2560
    buffer_load_ushort v14, v19, s[48:51], s57 offen offset:3072
    buffer_load_ushort v15, v19, s[48:51], s57 offen offset:3584
    s_waitcnt vmcnt(0)
    v_lshlrev_b32 v0, 16, v0
    v_mul_f32 v0, 0xbfb8aa3b, v0
    v_lshlrev_b32 v1, 16, v1
    v_mul_f32 v1, 0xbfb8aa3b, v1
    v_lshlrev_b32 v2, 16, v2
    v_mul_f32 v2, 0xbfb8aa3b, v2
    v_lshlrev_b32 v3, 16, v3
    v_mul_f32 v3, 0xbfb8aa3b, v3
    v_lshlrev_b32 v4, 16, v4
    v_mul_f32 v4, 0xbfb8aa3b, v4
    v_lshlrev_b32 v5, 16, v5
    v_mul_f32 v5, 0xbfb8aa3b, v5
    v_lshlrev_b32 v6, 16, v6
    v_mul_f32 v6, 0xbfb8aa3b, v6
    v_lshlrev_b32 v7, 16, v7
    v_mul_f32 v7, 0xbfb8aa3b, v7
    v_lshlrev_b32 v8, 16, v8
    v_mul_f32 v8, 0xbfb8aa3b, v8
    v_lshlrev_b32 v9, 16, v9
    v_mul_f32 v9, 0xbfb8aa3b, v9
    v_lshlrev_b32 v10, 16, v10
    v_mul_f32 v10, 0xbfb8aa3b, v10
    v_lshlrev_b32 v11, 16, v11
    v_mul_f32 v11, 0xbfb8aa3b, v11
    v_lshlrev_b32 v12, 16, v12
    v_mul_f32 v12, 0xbfb8aa3b, v12
    v_lshlrev_b32 v13, 16, v13
    v_mul_f32 v13, 0xbfb8aa3b, v13
    v_lshlrev_b32 v14, 16, v14
    v_mul_f32 v14, 0xbfb8aa3b, v14
    v_lshlrev_b32 v15, 16, v15
    v_mul_f32 v15, 0xbfb8aa3b, v15
    s_mul_i32 s58, s24, 157
    s_lshl_b32 s66, s26, 8
    s_barrier
sl_blk:
    buffer_load_dword v16, v18, s[36:39], s66 offen
    buffer_load_dword v17, v18, s[40:43], s66 offen
    s_waitcnt vmcnt(0)
    v_subrev_u32 v16, s58, v16
    v_cmp_gt_u32 s[4:5], s27, v16
    v_mul_u32_u24 v16, 272, v16
    v_mul_u32_u24 v20, 13358, v17
    v_lshrrev_b32 v20, 21, v20
    v_mad_u32_u24 v20, v20, 3, v17
    v_subrev_u32 v19, 4096, v20
    v_cmp_gt_u32 vcc, 5120, v19
    v_subrev_u32 v19, 5120, v20
    v_min_u32 v20, v20, v19
    v_cndmask_b32 v21, 32, 0, vcc
    v_and_b32 v19, 0xffffffe0, v20
    v_add3_u32 v20, v20, v19, v21
    v_and_b32 v17, 0x3fff, v20
    v_lshlrev_b32 v17, 8, v17
sl_edge:
    s_cmp_eq_u64 s[4:5], 0
    s_cbranch_scc1 sl_next
    s_ff1_i32_b64 s56, s[4:5]
    s_bitset0_b64 s[4:5], s56
    v_readlane_b32 s59, v16, s56
    v_readlane_b32 s60, v17, s56
    s_lshl_b32 s61, s66, 3
    s_lshl_b32 s56, s56, 5
    s_add_u32 s61, s61, s56
    s_buffer_load_dwordx8 s[8:15], s[44:47], s61
    v_mov_b32 v19, s60
    v_add_u32 v22, s59, v18
    buffer_load_dword v20, v19, s[28:31], 0 offen sc1
    ds_read_b32 v21, v22 offset:24576
    v_add_u32 v22, 68096, v22
    s_waitcnt vmcnt(0) lgkmcnt(0)
    v_lshlrev_b32 v21, 16, v21
    v_lshlrev_b32 v19, 16, v20
    v_add_f32 v21, v21, v19
    s_lshl_b32 s56, s8, 16
    s_and_b32 s57, s8, 0xffff0000
    v_fmac_f32 v21, s56, v0
    v_fmac_f32 v21, s57, v1
    s_lshl_b32 s56, s9, 16
    s_and_b32 s57, s9, 0xffff0000
    v_fmac_f32 v21, s56, v2
    v_fmac_f32 v21, s57, v3
    s_lshl_b32 s56, s10, 16
    s_and_b32 s57, s10, 0xffff0000
    v_fmac_f32 v21, s56, v4
    v_fmac_f32 v21, s57, v5
    s_lshl_b32 s56, s11, 16
    s_and_b32 s57, s11, 0xffff0000
    v_fmac_f32 v21, s56, v6
    v_fmac_f32 v21, s57, v7
    s_lshl_b32 s56, s12, 16
    s_and_b32 s57, s12, 0xffff0000
    v_fmac_f32 v21, s56, v8
    v_fmac_f32 v21, s57, v9
    s_lshl_b32 s56, s13, 16
    s_and_b32 s57, s13, 0xffff0000
    v_fmac_f32 v21, s56, v10
    v_fmac_f32 v21, s57, v11
    s_lshl_b32 s56, s14, 16
    s_and_b32 s57, s14, 0xffff0000
    v_fmac_f32 v21, s56, v12
    v_fmac_f32 v21, s57, v13
    s_lshl_b32 s56, s15, 16
    s_and_b32 s57, s15, 0xffff0000
    v_fmac_f32 v21, s56, v14
    v_fmac_f32 v21, s57, v15
    v_exp_f32 v21, v21
    s_nop 0
    v_add_f32 v21, 1.0, v21
    v_rcp_f32 v21, v21
    s_nop 0
    v_mul_f32 v21, v21, v20
    ds_add_f32 v22, v21
    s_branch sl_edge
sl_next:
    s_add_u32 s66, s66, 4096
    s_cmp_lt_u32 s66, 640000
    s_cbranch_scc1 sl_blk
    s_waitcnt lgkmcnt(0)
    s_barrier
    s_mul_i32 s62, s26, 10
    s_add_u32 s63, s62, 10
    s_min_u32 s62, s62, s27
    s_min_u32 s63, s63, s27
    s_mul_i32 s56, s26, 2720
    v_add_u32 v22, s56, v18
    v_add_u32 v19, 68096, v22
    ds_read_b32 v21, v22 offset:24576
    ds_read_b32 v20, v19 offset:0
    s_waitcnt lgkmcnt(0)
    v_and_b32 v21, 0xffff0000, v21
    v_add_f32 v21, v21, v20
    ds_write_b32 v22, v21 offset:24576
    ds_read_b32 v21, v22 offset:24848
    ds_read_b32 v20, v19 offset:272
    s_waitcnt lgkmcnt(0)
    v_and_b32 v21, 0xffff0000, v21
    v_add_f32 v21, v21, v20
    ds_write_b32 v22, v21 offset:24848
    ds_read_b32 v21, v22 offset:25120
    ds_read_b32 v20, v19 offset:544
    s_waitcnt lgkmcnt(0)
    v_and_b32 v21, 0xffff0000, v21
    v_add_f32 v21, v21, v20
    ds_write_b32 v22, v21 offset:25120
    ds_read_b32 v21, v22 offset:25392
    ds_read_b32 v20, v19 offset:816
    s_waitcnt lgkmcnt(0)
    v_and_b32 v21, 0xffff0000, v21
    v_add_f32 v21, v21, v20
    ds_write_b32 v22, v21 offset:25392
    ds_read_b32 v21, v22 offset:25664
    ds_read_b32 v20, v19 offset:1088
    s_waitcnt lgkmcnt(0)
    v_and_b32 v21, 0xffff0000, v21
    v_add_f32 v21, v21, v20
    ds_write_b32 v22, v21 offset:25664
    ds_read_b32 v21, v22 offset:25936
    ds_read_b32 v20, v19 offset:1360
    s_waitcnt lgkmcnt(0)
    v_and_b32 v21, 0xffff0000, v21
    v_add_f32 v21, v21, v20
    ds_write_b32 v22, v21 offset:25936
    ds_read_b32 v21, v22 offset:26208
    ds_read_b32 v20, v19 offset:1632
    s_waitcnt lgkmcnt(0)
    v_and_b32 v21, 0xffff0000, v21
    v_add_f32 v21, v21, v20
    ds_write_b32 v22, v21 offset:26208
    ds_read_b32 v21, v22 offset:26480
    ds_read_b32 v20, v19 offset:1904
    s_waitcnt lgkmcnt(0)
    v_and_b32 v21, 0xffff0000, v21
    v_add_f32 v21, v21, v20
    ds_write_b32 v22, v21 offset:26480
    ds_read_b32 v21, v22 offset:26752
    ds_read_b32 v20, v19 offset:2176
    s_waitcnt lgkmcnt(0)
    v_and_b32 v21, 0xffff0000, v21
    v_add_f32 v21, v21, v20
    ds_write_b32 v22, v21 offset:26752
    ds_read_b32 v21, v22 offset:27024
    ds_read_b32 v20, v19 offset:2448
    s_waitcnt lgkmcnt(0)
    v_and_b32 v21, 0xffff0000, v21
    v_add_f32 v21, v21, v20
    ds_write_b32 v22, v21 offset:27024
    s_branch k2_epi
k2_epi:
    s_sub_u32 s63, s63, s62
    s_add_u32 s57, s63, 3
    s_and_b32 s57, s57, -8
    s_add_u32 s57, s57, s62
    s_mul_i32 s57, s57, 272
    s_mul_i32 s58, s62, 272
    v_lshrrev_b32 v122, 3, v120
    v_lshrrev_b32 v123, 4, v120
    v_lshl_add_u32 v124, v122, 4, s58
    v_add_u32 v126, v123, v120
    v_lshl_add_u32 v124, v120, 5, v124
    v_lshl_add_u32 v126, v126, 4, s57
    s_waitcnt vmcnt(0)
    ds_read_b128 v[0:3], v124 offset:24576
    ds_read_b128 v[4:7], v124 offset:24592
    ds_read_b128 v[24:27], v126 offset:24576
    s_mul_i32 s56, s24, 157
    s_add_u32 s56, s56, s62
    s_lshl_b32 s56, s56, 2
    s_add_u32 s56, s56, s25
    s_lshl_b32 s56, s56, 7
    v_mad_u32_u24 v125, v122, 24, v120
    v_mad_u32_u24 v123, v123, 48, v120
    v_lshlrev_b32 v125, 4, v125
    v_lshlrev_b32 v123, 3, v123
    s_mov_b32 s4, 0xb5b8aa3b
    s_mov_b32 s5, 0xb5b8aa3b
    s_mov_b32 s6, 0x49800000
    s_mov_b32 s7, 0x49800000
    s_cmp_le_i32 s63, 4
    s_cbranch_scc1 k2_e4
k2_eloop:
    s_lshl_b32 s57, s63, 3
    s_bfm_b64 vcc, s57, 0
    s_cmp_ge_u32 s63, 8
    s_cselect_b64 vcc, -1, vcc
    s_waitcnt lgkmcnt(0)
    v_pk_mul_f32 v[8:9], v[0:1], s[4:5]
    v_pk_mul_f32 v[10:11], v[2:3], s[4:5]
    v_pk_mul_f32 v[12:13], v[4:5], s[4:5]
    v_pk_mul_f32 v[14:15], v[6:7], s[4:5]
    v_exp_f32 v8, v8
    v_exp_f32 v9, v9
    v_exp_f32 v10, v10
    v_exp_f32 v11, v11
    v_exp_f32 v12, v12
    v_exp_f32 v13, v13
    v_exp_f32 v14, v14
    v_exp_f32 v15, v15
    v_pk_fma_f32 v[8:9], v[8:9], s[6:7], s[6:7]
    v_pk_fma_f32 v[10:11], v[10:11], s[6:7], s[6:7]
    v_pk_fma_f32 v[12:13], v[12:13], s[6:7], s[6:7]
    v_pk_fma_f32 v[14:15], v[14:15], s[6:7], s[6:7]
    v_rcp_f32 v8, v8
    v_rcp_f32 v9, v9
    v_rcp_f32 v10, v10
    v_rcp_f32 v11, v11
    v_rcp_f32 v12, v12
    v_rcp_f32 v13, v13
    v_rcp_f32 v14, v14
    v_rcp_f32 v15, v15
    v_pk_mul_f32 v[0:1], v[0:1], v[8:9]
    v_pk_mul_f32 v[2:3], v[2:3], v[10:11]
    v_pk_mul_f32 v[4:5], v[4:5], v[12:13]
    v_pk_mul_f32 v[6:7], v[6:7], v[14:15]
    v_cvt_pk_bf16_f32 v16, v0, v1
    v_cvt_pk_bf16_f32 v17, v2, v3
    v_cvt_pk_bf16_f32 v18, v4, v5
    v_cvt_pk_bf16_f32 v19, v6, v7
    s_mov_b64 exec, vcc
    buffer_store_dwordx4 v[16:19], v125, s[32:35], s56 offen sc1
    s_mov_b64 exec, -1
    s_add_u32 s56, s56, 0x1000
    s_sub_i32 s63, s63, 8
    s_cmp_le_i32 s63, 4
    s_cbranch_scc1 k2_e4
    v_add_u32 v124, 2176, v124
    ds_read_b128 v[0:3], v124 offset:24576
    ds_read_b128 v[4:7], v124 offset:24592
    s_branch k2_eloop
k2_e4:
    s_cmp_le_i32 s63, 0
    s_cbranch_scc1 k2_done
    s_lshl_b32 s57, s63, 4
    s_bfm_b64 vcc, s57, 0
    s_cmp_ge_u32 s63, 4
    s_cselect_b64 vcc, -1, vcc
    s_waitcnt lgkmcnt(0)
    v_pk_mul_f32 v[32:33], v[24:25], s[4:5]
    v_pk_mul_f32 v[34:35], v[26:27], s[4:5]
    v_exp_f32 v32, v32
    v_exp_f32 v33, v33
    v_exp_f32 v34, v34
    v_exp_f32 v35, v35
    v_pk_fma_f32 v[32:33], v[32:33], s[6:7], s[6:7]
    v_pk_fma_f32 v[34:35], v[34:35], s[6:7], s[6:7]
    v_rcp_f32 v32, v32
    v_rcp_f32 v33, v33
    v_rcp_f32 v34, v34
    v_rcp_f32 v35, v35
    v_pk_mul_f32 v[24:25], v[24:25], v[32:33]
    v_pk_mul_f32 v[26:27], v[26:27], v[34:35]
    v_cvt_pk_bf16_f32 v40, v24, v25
    v_cvt_pk_bf16_f32 v41, v26, v27
    s_mov_b64 exec, vcc
    buffer_store_dwordx2 v[40:41], v123, s[32:35], s56 offen sc1
    s_mov_b64 exec, -1
k2_done:
k_end:
    s_endpgm
.section .rodata,"a"
.p2align 6
.amdhsa_kernel gather_scatter__edge_featured_mpnn_egc__graph_kernel
  .amdhsa_next_free_vgpr 128
  .amdhsa_next_free_sgpr 102
  .amdhsa_accum_offset 128
  .amdhsa_group_segment_fixed_size 0
  .amdhsa_kernarg_size 80
  .amdhsa_user_sgpr_count 2
  .amdhsa_user_sgpr_kernarg_segment_ptr 1
  .amdhsa_system_sgpr_workgroup_id_x 1
  .amdhsa_float_denorm_mode_32 3
.end_amdhsa_kernel
```
